```python
import torch

def _softmax(x, axis=-1):
    return torch.softmax(x, dim=axis)
def _gelu(x):
    return torch.nn.functional.gelu(x, approximate="tanh")
def _silu(x):
    return torch.nn.functional.silu(x)
def _sigmoid(x):
    return torch.sigmoid(x)
def _layernorm(x, axis=-1, eps=1e-5):
    m = x.mean(dim=axis, keepdim=True)
    v = x.var(dim=axis, keepdim=True, unbiased=False)
    return (x - m) / torch.sqrt(v + eps)
def _scatter_add(tgt, idx, src, axis=0):
    return tgt.clone().index_add_(axis, idx, src)
def _segment_sum(src, seg, n):
    out = torch.zeros((n,) + src.shape[1:], dtype=src.dtype)
    return out.index_add_(0, seg, src)
def _pad(x, pw):
    flat = tuple(v for pair in reversed(pw) for v in pair)
    return torch.nn.functional.pad(x, flat)

kernel_name = 'recurrent_scan__gqa_block_cached__glu_gated_swiglu__decode'

def setup_inputs():

    _w = (lambda a: (lambda t: t.to(torch.bfloat16) if t.is_floating_point() else t)(torch.as_tensor(a)))
    def _A_setup():
        B, Sq, D = 2, 1, 512
        Hq, Hkv, Sk, Dh = 32, 8, 32768, 128
        assert Hq % Hkv == 0, (Hq, Hkv)
        return {
            "x": _w((lambda *s: torch.randn(*s, dtype=torch.bfloat16) * 0.4)(B, Sq, D)),
            "k_cache": _w((lambda *s: torch.randn(*s, dtype=torch.bfloat16) * 1.6)(B, Hkv, Sk, Dh)),
            "v_cache": _w((lambda *s: torch.randn(*s, dtype=torch.bfloat16) * 1.6)(B, Hkv, Sk, Dh)),
            "wq": _w((lambda *s: torch.randn(*s, dtype=torch.bfloat16) * 1.6)(D, Hq * Dh) * (D ** -0.5)),
            "wo": _w((lambda *s: torch.randn(*s, dtype=torch.bfloat16) * 1.6)(Hq * Dh, D) * ((Hq * Dh) ** -0.5)),
        }
    _A_in = _A_setup()

    def _B_setup():
        B, S, D, F = 2, 1, 512, 1792
        return {
            "x": _w((lambda *s: torch.randn(*s, dtype=torch.bfloat16) * 0.4)(B, S, D)),
            "w1": _w((lambda *s: torch.randn(*s, dtype=torch.bfloat16) * 1.6)(D, F) * (2.0 / D) ** 0.5),
            "w3": _w((lambda *s: torch.randn(*s, dtype=torch.bfloat16) * 1.6)(D, F) * (2.0 / D) ** 0.5),
            "w2": _w((lambda *s: torch.randn(*s, dtype=torch.bfloat16) * 1.6)(F, D) * (2.0 / F) ** 0.5),
        }
    _B_in = _B_setup()

    return {
        "A_x": _A_in["x"],
        "A_k_cache": _A_in["k_cache"],
        "A_v_cache": _A_in["v_cache"],
        "A_wq": _A_in["wq"],
        "A_wo": _A_in["wo"],
        "B_x": _B_in["x"],
        "B_w1": _B_in["w1"],
        "B_w3": _B_in["w3"],
        "B_w2": _B_in["w2"],
    }

def reference(A_x, A_k_cache, A_v_cache, A_wq, A_wo, B_x, B_w1, B_w3, B_w2):
    def _A_ref(x, k_cache, v_cache, wq, wo):
        B, Sq, D = x.shape
        Hq, Dh = 32, 128
        Hkv = k_cache.shape[1]
        rep = Hq // Hkv
        q = (lambda x, *d: x.permute(*d))((x @ wq).reshape(B, Sq, Hq, Dh), 0, 2, 1, 3)
        k = (lambda x, n, axis: torch.repeat_interleave(x, n, dim=axis))(k_cache, rep, axis=1)
        v = (lambda x, n, axis: torch.repeat_interleave(x, n, dim=axis))(v_cache, rep, axis=1)
        scores = torch.einsum("bhqd,bhkd->bhqk", q, k) * (Dh ** -0.5)
        p = _softmax(scores, axis=-1)
        o = torch.einsum("bhqk,bhkd->bhqd", p, v)
        return (lambda x, *d: x.permute(*d))(o, 0, 2, 1, 3).reshape(B, Sq, Hq * Dh) @ wo

    def _B_ref(x, w1, w3, w2):
        gate = torch.einsum("bsd,df->bsf", x, w1)
        up = torch.einsum("bsd,df->bsf", x, w3)
        h = _silu(gate) * up
        out = torch.einsum("bsf,fd->bsd", h, w2)
        return out

    x = A_x
    xn = _layernorm(x, axis=-1)
    s = _A_ref(xn, A_k_cache, A_v_cache, A_wq, A_wo)
    g = _silu(_B_ref(xn, B_w1, B_w3, B_w2))
    return x + s * g
```

```asm
; @launch grid=(256,1,1) block=(256,1,1) lds=13568
.amdgcn_target "amdgcn-amd-amdhsa--gfx950"
.text
.globl recurrent_scan__gqa_block_cached__glu_gated_swiglu__decode_kernel
.p2align 8
.type recurrent_scan__gqa_block_cached__glu_gated_swiglu__decode_kernel,@function
recurrent_scan__gqa_block_cached__glu_gated_swiglu__decode_kernel:
    s_cmp_ge_u32 s2, 256
    s_cbranch_scc1 L_end
    s_load_dwordx16 s[16:31], s[0:1], 0
    s_load_dwordx8 s[32:39], s[0:1], 64
    v_lshrrev_b32 v1, 6, v0
    v_and_b32 v0, 63, v0
    s_and_b32 s4, s2, 7
    v_readfirstlane_b32 s3, v1
    s_lshr_b32 s5, s2, 3
    s_and_b32 s6, s5, 15
    s_lshr_b32 s7, s5, 4
    s_lshl_b32 s8, s7, 3
    s_add_u32 s8, s8, s4
    s_mov_b32 s82, 1069066811
    s_mov_b32 s83, 3216550459
    s_mov_b32 s84, 1035273459
    s_cmp_eq_u32 s3, 0
    s_cbranch_scc1 L_helper
    v_and_b32 v7, 15, v0
    v_lshrrev_b32 v8, 4, v0
    v_and_b32 v9, 3, v7
    v_lshrrev_b32 v10, 2, v7
    v_lshl_add_u32 v9, v9, 2, v10
    v_lshlrev_b32 v1, 8, v9
    v_lshl_add_u32 v1, v8, 4, v1
    v_lshlrev_b32 v2, 4, v0
    v_mov_b32 v3, 0
    v_mov_b32 v4, 0
    v_mov_b32 v11, 0xffff
    v_mov_b32 v12, 0xffff0000
    v_cmp_eq_u32 vcc, 0, v10
    s_nop 1
    v_cndmask_b32 v3, v3, v11, vcc
    v_cmp_eq_u32 vcc, 1, v10
    s_nop 1
    v_cndmask_b32 v3, v3, v12, vcc
    v_cmp_eq_u32 vcc, 2, v10
    s_nop 1
    v_cndmask_b32 v4, v4, v11, vcc
    v_cmp_eq_u32 vcc, 3, v10
    s_nop 1
    v_cndmask_b32 v4, v4, v12, vcc
    v_and_b32 v13, 3, v7
    v_lshlrev_b32 v13, 8, v13
    v_lshl_add_u32 v13, v8, 4, v13
    s_sub_u32 s9, s3, 1
    v_lshlrev_b32 v14, 5, v7
    v_lshl_add_u32 v14, v8, 2, v14
    s_lshl_b32 s10, s9, 11
    v_add_u32 v14, s10, v14
    v_and_b32 v15, 3, v0
    v_lshlrev_b32 v15, 3, v15
    s_lshl_b32 s10, s9, 5
    v_add_u32 v15, s10, v15
    s_mul_i32 s13, s6, 125
    s_mul_i32 s14, s6, 129
    s_sub_u32 s14, s14, 16
    s_cmp_lt_u32 s6, 4
    s_cselect_b32 s13, s13, s14
    s_cselect_b32 s14, 0, 4
    s_add_u32 s14, s14, 125
    s_lshl_b32 s12, s8, 23
    s_lshl_b32 s13, s13, 12
    s_add_u32 s15, s12, s13
    v_mov_b32 v44, 12416
    v_mov_b32 v45, 1
    v_mov_b32 v5, 0xff800000
    v_mov_b32 v6, 0
    v_mov_b32 v20, 0
    v_mov_b32 v21, 0
    v_mov_b32 v22, 0
    v_mov_b32 v23, 0
    v_mov_b32 v24, 0
    v_mov_b32 v25, 0
    v_mov_b32 v26, 0
    v_mov_b32 v27, 0
    s_waitcnt lgkmcnt(0)
    s_mov_b32 s40, s18
    s_and_b32 s41, s19, 0xffff
    s_mov_b32 s42, 134217728
    s_mov_b32 s43, 0x20000
    s_mov_b32 s44, s20
    s_and_b32 s45, s21, 0xffff
    s_mov_b32 s46, 134217728
    s_mov_b32 s47, 0x20000
    s_add_u32 s60, s9, 0
    s_lshl_b32 s13, s60, 12
    s_add_u32 s12, s15, s13
    s_cmp_lt_u32 s60, s14
    s_cselect_b32 s12, s12, 0x7ff00000
    buffer_load_dwordx4 a[0:3], v1, s[40:43], s12 offen offset:0 nt
    buffer_load_dwordx4 a[4:7], v1, s[40:43], s12 offen offset:64 nt
    buffer_load_dwordx4 a[8:11], v1, s[40:43], s12 offen offset:128 nt
    buffer_load_dwordx4 a[12:15], v1, s[40:43], s12 offen offset:192 nt
    buffer_load_dwordx4 a[16:19], v2, s[44:47], s12 offen offset:0 nt
    buffer_load_dwordx4 a[20:23], v2, s[44:47], s12 offen offset:1024 nt
    buffer_load_dwordx4 a[24:27], v2, s[44:47], s12 offen offset:2048 nt
    buffer_load_dwordx4 a[28:31], v2, s[44:47], s12 offen offset:3072 nt
    s_barrier
    s_add_u32 s61, s9, 3
    s_lshl_b32 s13, s61, 12
    s_add_u32 s12, s15, s13
    s_cmp_lt_u32 s61, s14
    s_cselect_b32 s12, s12, 0x7ff00000
    buffer_load_dwordx4 a[32:35], v1, s[40:43], s12 offen offset:0 nt
    buffer_load_dwordx4 a[36:39], v1, s[40:43], s12 offen offset:64 nt
    buffer_load_dwordx4 a[40:43], v1, s[40:43], s12 offen offset:128 nt
    buffer_load_dwordx4 a[44:47], v1, s[40:43], s12 offen offset:192 nt
    buffer_load_dwordx4 a[48:51], v2, s[44:47], s12 offen offset:0 nt
    buffer_load_dwordx4 a[52:55], v2, s[44:47], s12 offen offset:1024 nt
    buffer_load_dwordx4 a[56:59], v2, s[44:47], s12 offen offset:2048 nt
    buffer_load_dwordx4 a[60:63], v2, s[44:47], s12 offen offset:3072 nt
    s_waitcnt vmcnt(8)
    s_add_u32 s62, s9, 6
    s_lshl_b32 s13, s62, 12
    s_add_u32 s12, s15, s13
    s_cmp_lt_u32 s62, s14
    s_cselect_b32 s12, s12, 0x7ff00000
    buffer_load_dwordx4 a[64:67], v1, s[40:43], s12 offen offset:0 nt
    buffer_load_dwordx4 a[68:71], v1, s[40:43], s12 offen offset:64 nt
    buffer_load_dwordx4 a[72:75], v1, s[40:43], s12 offen offset:128 nt
    buffer_load_dwordx4 a[76:79], v1, s[40:43], s12 offen offset:192 nt
    buffer_load_dwordx4 a[80:83], v2, s[44:47], s12 offen offset:0 nt
    buffer_load_dwordx4 a[84:87], v2, s[44:47], s12 offen offset:1024 nt
    buffer_load_dwordx4 a[88:91], v2, s[44:47], s12 offen offset:2048 nt
    buffer_load_dwordx4 a[92:95], v2, s[44:47], s12 offen offset:3072 nt
    s_waitcnt vmcnt(8)
    s_add_u32 s63, s9, 9
    s_lshl_b32 s13, s63, 12
    s_add_u32 s12, s15, s13
    s_cmp_lt_u32 s63, s14
    s_cselect_b32 s12, s12, 0x7ff00000
    buffer_load_dwordx4 a[96:99], v1, s[40:43], s12 offen offset:0 nt
    buffer_load_dwordx4 a[100:103], v1, s[40:43], s12 offen offset:64 nt
    buffer_load_dwordx4 a[104:107], v1, s[40:43], s12 offen offset:128 nt
    buffer_load_dwordx4 a[108:111], v1, s[40:43], s12 offen offset:192 nt
    buffer_load_dwordx4 a[112:115], v2, s[44:47], s12 offen offset:0 nt
    buffer_load_dwordx4 a[116:119], v2, s[44:47], s12 offen offset:1024 nt
    buffer_load_dwordx4 a[120:123], v2, s[44:47], s12 offen offset:2048 nt
    buffer_load_dwordx4 a[124:127], v2, s[44:47], s12 offen offset:3072 nt
    s_waitcnt vmcnt(8)
    s_add_u32 s64, s9, 12
    s_lshl_b32 s13, s64, 12
    s_add_u32 s12, s15, s13
    s_cmp_lt_u32 s64, s14
    s_cselect_b32 s12, s12, 0x7ff00000
    buffer_load_dwordx4 a[128:131], v1, s[40:43], s12 offen offset:0 nt
    buffer_load_dwordx4 a[132:135], v1, s[40:43], s12 offen offset:64 nt
    buffer_load_dwordx4 a[136:139], v1, s[40:43], s12 offen offset:128 nt
    buffer_load_dwordx4 a[140:143], v1, s[40:43], s12 offen offset:192 nt
    buffer_load_dwordx4 a[144:147], v2, s[44:47], s12 offen offset:0 nt
    buffer_load_dwordx4 a[148:151], v2, s[44:47], s12 offen offset:1024 nt
    buffer_load_dwordx4 a[152:155], v2, s[44:47], s12 offen offset:2048 nt
    buffer_load_dwordx4 a[156:159], v2, s[44:47], s12 offen offset:3072 nt
    s_waitcnt vmcnt(8)
    s_add_u32 s65, s9, 15
    s_lshl_b32 s13, s65, 12
    s_add_u32 s12, s15, s13
    s_cmp_lt_u32 s65, s14
    s_cselect_b32 s12, s12, 0x7ff00000
    buffer_load_dwordx4 a[160:163], v1, s[40:43], s12 offen offset:0 nt
    buffer_load_dwordx4 a[164:167], v1, s[40:43], s12 offen offset:64 nt
    buffer_load_dwordx4 a[168:171], v1, s[40:43], s12 offen offset:128 nt
    buffer_load_dwordx4 a[172:175], v1, s[40:43], s12 offen offset:192 nt
    buffer_load_dwordx4 a[176:179], v2, s[44:47], s12 offen offset:0 nt
    buffer_load_dwordx4 a[180:183], v2, s[44:47], s12 offen offset:1024 nt
    buffer_load_dwordx4 a[184:187], v2, s[44:47], s12 offen offset:2048 nt
    buffer_load_dwordx4 a[188:191], v2, s[44:47], s12 offen offset:3072 nt
    s_waitcnt vmcnt(8)
    s_add_u32 s66, s9, 18
    s_lshl_b32 s13, s66, 12
    s_add_u32 s12, s15, s13
    s_cmp_lt_u32 s66, s14
    s_cselect_b32 s12, s12, 0x7ff00000
    buffer_load_dwordx4 a[192:195], v1, s[40:43], s12 offen offset:0 nt
    buffer_load_dwordx4 a[196:199], v1, s[40:43], s12 offen offset:64 nt
    buffer_load_dwordx4 a[200:203], v1, s[40:43], s12 offen offset:128 nt
    buffer_load_dwordx4 a[204:207], v1, s[40:43], s12 offen offset:192 nt
    buffer_load_dwordx4 a[208:211], v2, s[44:47], s12 offen offset:0 nt
    buffer_load_dwordx4 a[212:215], v2, s[44:47], s12 offen offset:1024 nt
    buffer_load_dwordx4 a[216:219], v2, s[44:47], s12 offen offset:2048 nt
    buffer_load_dwordx4 a[220:223], v2, s[44:47], s12 offen offset:3072 nt
    s_waitcnt vmcnt(8)
    s_add_u32 s67, s9, 21
    s_lshl_b32 s13, s67, 12
    s_add_u32 s12, s15, s13
    s_cmp_lt_u32 s67, s14
    s_cselect_b32 s12, s12, 0x7ff00000
    buffer_load_dwordx4 a[224:227], v1, s[40:43], s12 offen offset:0 nt
    buffer_load_dwordx4 a[228:231], v1, s[40:43], s12 offen offset:64 nt
    buffer_load_dwordx4 a[232:235], v1, s[40:43], s12 offen offset:128 nt
    buffer_load_dwordx4 a[236:239], v1, s[40:43], s12 offen offset:192 nt
    buffer_load_dwordx4 a[240:243], v2, s[44:47], s12 offen offset:0 nt
    buffer_load_dwordx4 a[244:247], v2, s[44:47], s12 offen offset:1024 nt
    buffer_load_dwordx4 a[248:251], v2, s[44:47], s12 offen offset:2048 nt
    buffer_load_dwordx4 a[252:255], v2, s[44:47], s12 offen offset:3072 nt
    s_mov_b64 exec, 1
    ds_add_rtn_u32 v46, v44, v45
    s_mov_b64 exec, -1
    s_mov_b32 s90, 65536
L_poll_1:
    ds_read_b32 v7, v44 offset:4
    s_waitcnt lgkmcnt(0)
    v_cmp_eq_u32 vcc, 0, v7
    s_cbranch_vccz L_pdone_2
    s_sleep 2
    s_sub_u32 s90, s90, 1
    s_cmp_lg_u32 s90, 0
    s_cbranch_scc1 L_poll_1
L_pdone_2:
    ds_read_b128 v[48:51], v13 offset:2048
    ds_read_b128 v[52:55], v13 offset:2112
    ds_read_b128 v[56:59], v13 offset:2176
    ds_read_b128 v[60:63], v13 offset:2240
    s_waitcnt lgkmcnt(0)
L_sloop:
    s_cmp_ge_u32 s60, s14
    s_cbranch_scc1 L_sdone
    s_waitcnt vmcnt(60)
    v_mfma_f32_16x16x32_bf16 v[16:19], a[0:3], v[48:51], 0
    v_mfma_f32_16x16x32_bf16 v[16:19], a[4:7], v[52:55], v[16:19]
    v_mfma_f32_16x16x32_bf16 v[16:19], a[8:11], v[56:59], v[16:19]
    v_mfma_f32_16x16x32_bf16 v[16:19], a[12:15], v[60:63], v[16:19]
    s_nop 7
    v_cvt_pk_bf16_f32 v36, v16, v17
    v_cvt_pk_bf16_f32 v37, v18, v19
    v_lshlrev_b32 v40, 16, v36
    v_and_b32 v41, 0xffff0000, v36
    v_lshlrev_b32 v42, 16, v37
    v_and_b32 v43, 0xffff0000, v37
    v_mul_f32 v40, s84, v40
    v_mul_f32 v41, s84, v41
    v_mul_f32 v42, s84, v42
    v_mul_f32 v43, s84, v43
    v_cvt_pk_bf16_f32 v36, v40, v41
    v_cvt_pk_bf16_f32 v37, v42, v43
    v_lshlrev_b32 v40, 16, v36
    v_and_b32 v41, 0xffff0000, v36
    v_lshlrev_b32 v42, 16, v37
    v_and_b32 v43, 0xffff0000, v37
    v_max3_f32 v7, v40, v41, v42
    v_max3_f32 v7, v7, v43, v5
    v_mov_b32 v8, v7
    s_nop 1
    v_permlane16_swap_b32 v7, v8
    s_nop 0
    v_max_f32 v7, v7, v8
    v_mov_b32 v8, v7
    s_nop 1
    v_permlane32_swap_b32 v7, v8
    s_nop 0
    v_max_f32 v7, v7, v8
    v_sub_f32 v9, v5, v7
    v_mul_f32 v10, s82, v7
    v_mul_f32 v9, s82, v9
    v_mov_b32 v5, v7
    v_fma_f32 v40, v40, s82, -v10
    v_fma_f32 v41, v41, s82, -v10
    v_fma_f32 v42, v42, s82, -v10
    v_fma_f32 v43, v43, s82, -v10
    v_exp_f32 v9, v9
    v_exp_f32 v40, v40
    v_exp_f32 v41, v41
    v_exp_f32 v42, v42
    v_exp_f32 v43, v43
    s_nop 0
    v_add_f32 v11, v40, v41
    v_add_f32 v12, v42, v43
    v_cvt_pk_bf16_f32 v36, v40, v40
    v_cvt_pk_bf16_f32 v37, v41, v41
    v_cvt_pk_bf16_f32 v38, v42, v42
    v_cvt_pk_bf16_f32 v39, v43, v43
    v_add_f32 v11, v11, v12
    v_fma_f32 v6, v6, v9, v11
    v_and_b32 v28, v3, v36
    v_and_b32 v29, v4, v36
    v_and_b32 v30, v3, v37
    v_and_b32 v31, v4, v37
    v_and_b32 v32, v3, v38
    v_and_b32 v33, v4, v38
    v_and_b32 v34, v3, v39
    v_and_b32 v35, v4, v39
    v_mul_f32_dpp v20, v9, v20 quad_perm:[0,0,0,0] row_mask:0xf bank_mask:0xf
    v_mul_f32_dpp v24, v9, v24 quad_perm:[0,0,0,0] row_mask:0xf bank_mask:0xf
    v_mul_f32_dpp v21, v9, v21 quad_perm:[1,1,1,1] row_mask:0xf bank_mask:0xf
    v_mul_f32_dpp v25, v9, v25 quad_perm:[1,1,1,1] row_mask:0xf bank_mask:0xf
    v_mul_f32_dpp v22, v9, v22 quad_perm:[2,2,2,2] row_mask:0xf bank_mask:0xf
    v_mul_f32_dpp v26, v9, v26 quad_perm:[2,2,2,2] row_mask:0xf bank_mask:0xf
    v_mul_f32_dpp v23, v9, v23 quad_perm:[3,3,3,3] row_mask:0xf bank_mask:0xf
    v_mul_f32_dpp v27, v9, v27 quad_perm:[3,3,3,3] row_mask:0xf bank_mask:0xf
    s_waitcnt vmcnt(56)
    s_nop 0
    v_mfma_f32_16x16x16_bf16 v[20:23], v[28:29], a[16:17], v[20:23]
    v_mfma_f32_16x16x16_bf16 v[24:27], v[28:29], a[18:19], v[24:27]
    v_mfma_f32_16x16x16_bf16 v[20:23], v[30:31], a[20:21], v[20:23]
    v_mfma_f32_16x16x16_bf16 v[24:27], v[30:31], a[22:23], v[24:27]
    v_mfma_f32_16x16x16_bf16 v[20:23], v[32:33], a[24:25], v[20:23]
    v_mfma_f32_16x16x16_bf16 v[24:27], v[32:33], a[26:27], v[24:27]
    v_mfma_f32_16x16x16_bf16 v[20:23], v[34:35], a[28:29], v[20:23]
    v_mfma_f32_16x16x16_bf16 v[24:27], v[34:35], a[30:31], v[24:27]
    s_waitcnt lgkmcnt(0)
    v_readfirstlane_b32 s60, v46
    s_waitcnt vmcnt(32)
    s_lshl_b32 s13, s60, 12
    s_add_u32 s12, s15, s13
    s_cmp_lt_u32 s60, s14
    s_cselect_b32 s12, s12, 0x7ff00000
    buffer_load_dwordx4 a[0:3], v1, s[40:43], s12 offen offset:0 nt
    buffer_load_dwordx4 a[4:7], v1, s[40:43], s12 offen offset:64 nt
    buffer_load_dwordx4 a[8:11], v1, s[40:43], s12 offen offset:128 nt
    buffer_load_dwordx4 a[12:15], v1, s[40:43], s12 offen offset:192 nt
    buffer_load_dwordx4 a[16:19], v2, s[44:47], s12 offen offset:0 nt
    buffer_load_dwordx4 a[20:23], v2, s[44:47], s12 offen offset:1024 nt
    buffer_load_dwordx4 a[24:27], v2, s[44:47], s12 offen offset:2048 nt
    buffer_load_dwordx4 a[28:31], v2, s[44:47], s12 offen offset:3072 nt
    s_mov_b64 exec, 1
    ds_add_rtn_u32 v46, v44, v45
    s_mov_b64 exec, -1
    s_cmp_ge_u32 s61, s14
    s_cbranch_scc1 L_sdone
    s_waitcnt vmcnt(60)
    v_mfma_f32_16x16x32_bf16 v[16:19], a[32:35], v[48:51], 0
    v_mfma_f32_16x16x32_bf16 v[16:19], a[36:39], v[52:55], v[16:19]
    v_mfma_f32_16x16x32_bf16 v[16:19], a[40:43], v[56:59], v[16:19]
    v_mfma_f32_16x16x32_bf16 v[16:19], a[44:47], v[60:63], v[16:19]
    s_nop 7
    v_cvt_pk_bf16_f32 v36, v16, v17
    v_cvt_pk_bf16_f32 v37, v18, v19
    v_lshlrev_b32 v40, 16, v36
    v_and_b32 v41, 0xffff0000, v36
    v_lshlrev_b32 v42, 16, v37
    v_and_b32 v43, 0xffff0000, v37
    v_mul_f32 v40, s84, v40
    v_mul_f32 v41, s84, v41
    v_mul_f32 v42, s84, v42
    v_mul_f32 v43, s84, v43
    v_cvt_pk_bf16_f32 v36, v40, v41
    v_cvt_pk_bf16_f32 v37, v42, v43
    v_lshlrev_b32 v40, 16, v36
    v_and_b32 v41, 0xffff0000, v36
    v_lshlrev_b32 v42, 16, v37
    v_and_b32 v43, 0xffff0000, v37
    v_max3_f32 v7, v40, v41, v42
    v_max3_f32 v7, v7, v43, v5
    v_mov_b32 v8, v7
    s_nop 1
    v_permlane16_swap_b32 v7, v8
    s_nop 0
    v_max_f32 v7, v7, v8
    v_mov_b32 v8, v7
    s_nop 1
    v_permlane32_swap_b32 v7, v8
    s_nop 0
    v_max_f32 v7, v7, v8
    v_sub_f32 v9, v5, v7
    v_mul_f32 v10, s82, v7
    v_mul_f32 v9, s82, v9
    v_mov_b32 v5, v7
    v_fma_f32 v40, v40, s82, -v10
    v_fma_f32 v41, v41, s82, -v10
    v_fma_f32 v42, v42, s82, -v10
    v_fma_f32 v43, v43, s82, -v10
    v_exp_f32 v9, v9
    v_exp_f32 v40, v40
    v_exp_f32 v41, v41
    v_exp_f32 v42, v42
    v_exp_f32 v43, v43
    s_nop 0
    v_add_f32 v11, v40, v41
    v_add_f32 v12, v42, v43
    v_cvt_pk_bf16_f32 v36, v40, v40
    v_cvt_pk_bf16_f32 v37, v41, v41
    v_cvt_pk_bf16_f32 v38, v42, v42
    v_cvt_pk_bf16_f32 v39, v43, v43
    v_add_f32 v11, v11, v12
    v_fma_f32 v6, v6, v9, v11
    v_and_b32 v28, v3, v36
    v_and_b32 v29, v4, v36
    v_and_b32 v30, v3, v37
    v_and_b32 v31, v4, v37
    v_and_b32 v32, v3, v38
    v_and_b32 v33, v4, v38
    v_and_b32 v34, v3, v39
    v_and_b32 v35, v4, v39
    v_mul_f32_dpp v20, v9, v20 quad_perm:[0,0,0,0] row_mask:0xf bank_mask:0xf
    v_mul_f32_dpp v24, v9, v24 quad_perm:[0,0,0,0] row_mask:0xf bank_mask:0xf
    v_mul_f32_dpp v21, v9, v21 quad_perm:[1,1,1,1] row_mask:0xf bank_mask:0xf
    v_mul_f32_dpp v25, v9, v25 quad_perm:[1,1,1,1] row_mask:0xf bank_mask:0xf
    v_mul_f32_dpp v22, v9, v22 quad_perm:[2,2,2,2] row_mask:0xf bank_mask:0xf
    v_mul_f32_dpp v26, v9, v26 quad_perm:[2,2,2,2] row_mask:0xf bank_mask:0xf
    v_mul_f32_dpp v23, v9, v23 quad_perm:[3,3,3,3] row_mask:0xf bank_mask:0xf
    v_mul_f32_dpp v27, v9, v27 quad_perm:[3,3,3,3] row_mask:0xf bank_mask:0xf
    s_waitcnt vmcnt(56)
    s_nop 0
    v_mfma_f32_16x16x16_bf16 v[20:23], v[28:29], a[48:49], v[20:23]
    v_mfma_f32_16x16x16_bf16 v[24:27], v[28:29], a[50:51], v[24:27]
    v_mfma_f32_16x16x16_bf16 v[20:23], v[30:31], a[52:53], v[20:23]
    v_mfma_f32_16x16x16_bf16 v[24:27], v[30:31], a[54:55], v[24:27]
    v_mfma_f32_16x16x16_bf16 v[20:23], v[32:33], a[56:57], v[20:23]
    v_mfma_f32_16x16x16_bf16 v[24:27], v[32:33], a[58:59], v[24:27]
    v_mfma_f32_16x16x16_bf16 v[20:23], v[34:35], a[60:61], v[20:23]
    v_mfma_f32_16x16x16_bf16 v[24:27], v[34:35], a[62:63], v[24:27]
    s_waitcnt lgkmcnt(0)
    v_readfirstlane_b32 s61, v46
    s_waitcnt vmcnt(32)
    s_lshl_b32 s13, s61, 12
    s_add_u32 s12, s15, s13
    s_cmp_lt_u32 s61, s14
    s_cselect_b32 s12, s12, 0x7ff00000
    buffer_load_dwordx4 a[32:35], v1, s[40:43], s12 offen offset:0 nt
    buffer_load_dwordx4 a[36:39], v1, s[40:43], s12 offen offset:64 nt
    buffer_load_dwordx4 a[40:43], v1, s[40:43], s12 offen offset:128 nt
    buffer_load_dwordx4 a[44:47], v1, s[40:43], s12 offen offset:192 nt
    buffer_load_dwordx4 a[48:51], v2, s[44:47], s12 offen offset:0 nt
    buffer_load_dwordx4 a[52:55], v2, s[44:47], s12 offen offset:1024 nt
    buffer_load_dwordx4 a[56:59], v2, s[44:47], s12 offen offset:2048 nt
    buffer_load_dwordx4 a[60:63], v2, s[44:47], s12 offen offset:3072 nt
    s_mov_b64 exec, 1
    ds_add_rtn_u32 v46, v44, v45
    s_mov_b64 exec, -1
    s_cmp_ge_u32 s62, s14
    s_cbranch_scc1 L_sdone
    s_waitcnt vmcnt(60)
    v_mfma_f32_16x16x32_bf16 v[16:19], a[64:67], v[48:51], 0
    v_mfma_f32_16x16x32_bf16 v[16:19], a[68:71], v[52:55], v[16:19]
    v_mfma_f32_16x16x32_bf16 v[16:19], a[72:75], v[56:59], v[16:19]
    v_mfma_f32_16x16x32_bf16 v[16:19], a[76:79], v[60:63], v[16:19]
    s_nop 7
    v_cvt_pk_bf16_f32 v36, v16, v17
    v_cvt_pk_bf16_f32 v37, v18, v19
    v_lshlrev_b32 v40, 16, v36
    v_and_b32 v41, 0xffff0000, v36
    v_lshlrev_b32 v42, 16, v37
    v_and_b32 v43, 0xffff0000, v37
    v_mul_f32 v40, s84, v40
    v_mul_f32 v41, s84, v41
    v_mul_f32 v42, s84, v42
    v_mul_f32 v43, s84, v43
    v_cvt_pk_bf16_f32 v36, v40, v41
    v_cvt_pk_bf16_f32 v37, v42, v43
    v_lshlrev_b32 v40, 16, v36
    v_and_b32 v41, 0xffff0000, v36
    v_lshlrev_b32 v42, 16, v37
    v_and_b32 v43, 0xffff0000, v37
    v_max3_f32 v7, v40, v41, v42
    v_max3_f32 v7, v7, v43, v5
    v_mov_b32 v8, v7
    s_nop 1
    v_permlane16_swap_b32 v7, v8
    s_nop 0
    v_max_f32 v7, v7, v8
    v_mov_b32 v8, v7
    s_nop 1
    v_permlane32_swap_b32 v7, v8
    s_nop 0
    v_max_f32 v7, v7, v8
    v_sub_f32 v9, v5, v7
    v_mul_f32 v10, s82, v7
    v_mul_f32 v9, s82, v9
    v_mov_b32 v5, v7
    v_fma_f32 v40, v40, s82, -v10
    v_fma_f32 v41, v41, s82, -v10
    v_fma_f32 v42, v42, s82, -v10
    v_fma_f32 v43, v43, s82, -v10
    v_exp_f32 v9, v9
    v_exp_f32 v40, v40
    v_exp_f32 v41, v41
    v_exp_f32 v42, v42
    v_exp_f32 v43, v43
    s_nop 0
    v_add_f32 v11, v40, v41
    v_add_f32 v12, v42, v43
    v_cvt_pk_bf16_f32 v36, v40, v40
    v_cvt_pk_bf16_f32 v37, v41, v41
    v_cvt_pk_bf16_f32 v38, v42, v42
    v_cvt_pk_bf16_f32 v39, v43, v43
    v_add_f32 v11, v11, v12
    v_fma_f32 v6, v6, v9, v11
    v_and_b32 v28, v3, v36
    v_and_b32 v29, v4, v36
    v_and_b32 v30, v3, v37
    v_and_b32 v31, v4, v37
    v_and_b32 v32, v3, v38
    v_and_b32 v33, v4, v38
    v_and_b32 v34, v3, v39
    v_and_b32 v35, v4, v39
    v_mul_f32_dpp v20, v9, v20 quad_perm:[0,0,0,0] row_mask:0xf bank_mask:0xf
    v_mul_f32_dpp v24, v9, v24 quad_perm:[0,0,0,0] row_mask:0xf bank_mask:0xf
    v_mul_f32_dpp v21, v9, v21 quad_perm:[1,1,1,1] row_mask:0xf bank_mask:0xf
    v_mul_f32_dpp v25, v9, v25 quad_perm:[1,1,1,1] row_mask:0xf bank_mask:0xf
    v_mul_f32_dpp v22, v9, v22 quad_perm:[2,2,2,2] row_mask:0xf bank_mask:0xf
    v_mul_f32_dpp v26, v9, v26 quad_perm:[2,2,2,2] row_mask:0xf bank_mask:0xf
    v_mul_f32_dpp v23, v9, v23 quad_perm:[3,3,3,3] row_mask:0xf bank_mask:0xf
    v_mul_f32_dpp v27, v9, v27 quad_perm:[3,3,3,3] row_mask:0xf bank_mask:0xf
    s_waitcnt vmcnt(56)
    s_nop 0
    v_mfma_f32_16x16x16_bf16 v[20:23], v[28:29], a[80:81], v[20:23]
    v_mfma_f32_16x16x16_bf16 v[24:27], v[28:29], a[82:83], v[24:27]
    v_mfma_f32_16x16x16_bf16 v[20:23], v[30:31], a[84:85], v[20:23]
    v_mfma_f32_16x16x16_bf16 v[24:27], v[30:31], a[86:87], v[24:27]
    v_mfma_f32_16x16x16_bf16 v[20:23], v[32:33], a[88:89], v[20:23]
    v_mfma_f32_16x16x16_bf16 v[24:27], v[32:33], a[90:91], v[24:27]
    v_mfma_f32_16x16x16_bf16 v[20:23], v[34:35], a[92:93], v[20:23]
    v_mfma_f32_16x16x16_bf16 v[24:27], v[34:35], a[94:95], v[24:27]
    s_waitcnt lgkmcnt(0)
    v_readfirstlane_b32 s62, v46
    s_waitcnt vmcnt(32)
    s_lshl_b32 s13, s62, 12
    s_add_u32 s12, s15, s13
    s_cmp_lt_u32 s62, s14
    s_cselect_b32 s12, s12, 0x7ff00000
    buffer_load_dwordx4 a[64:67], v1, s[40:43], s12 offen offset:0 nt
    buffer_load_dwordx4 a[68:71], v1, s[40:43], s12 offen offset:64 nt
    buffer_load_dwordx4 a[72:75], v1, s[40:43], s12 offen offset:128 nt
    buffer_load_dwordx4 a[76:79], v1, s[40:43], s12 offen offset:192 nt
    buffer_load_dwordx4 a[80:83], v2, s[44:47], s12 offen offset:0 nt
    buffer_load_dwordx4 a[84:87], v2, s[44:47], s12 offen offset:1024 nt
    buffer_load_dwordx4 a[88:91], v2, s[44:47], s12 offen offset:2048 nt
    buffer_load_dwordx4 a[92:95], v2, s[44:47], s12 offen offset:3072 nt
    s_mov_b64 exec, 1
    ds_add_rtn_u32 v46, v44, v45
    s_mov_b64 exec, -1
    s_cmp_ge_u32 s63, s14
    s_cbranch_scc1 L_sdone
    s_waitcnt vmcnt(60)
    v_mfma_f32_16x16x32_bf16 v[16:19], a[96:99], v[48:51], 0
    v_mfma_f32_16x16x32_bf16 v[16:19], a[100:103], v[52:55], v[16:19]
    v_mfma_f32_16x16x32_bf16 v[16:19], a[104:107], v[56:59], v[16:19]
    v_mfma_f32_16x16x32_bf16 v[16:19], a[108:111], v[60:63], v[16:19]
    s_nop 7
    v_cvt_pk_bf16_f32 v36, v16, v17
    v_cvt_pk_bf16_f32 v37, v18, v19
    v_lshlrev_b32 v40, 16, v36
    v_and_b32 v41, 0xffff0000, v36
    v_lshlrev_b32 v42, 16, v37
    v_and_b32 v43, 0xffff0000, v37
    v_mul_f32 v40, s84, v40
    v_mul_f32 v41, s84, v41
    v_mul_f32 v42, s84, v42
    v_mul_f32 v43, s84, v43
    v_cvt_pk_bf16_f32 v36, v40, v41
    v_cvt_pk_bf16_f32 v37, v42, v43
    v_lshlrev_b32 v40, 16, v36
    v_and_b32 v41, 0xffff0000, v36
    v_lshlrev_b32 v42, 16, v37
    v_and_b32 v43, 0xffff0000, v37
    v_max3_f32 v7, v40, v41, v42
    v_max3_f32 v7, v7, v43, v5
    v_mov_b32 v8, v7
    s_nop 1
    v_permlane16_swap_b32 v7, v8
    s_nop 0
    v_max_f32 v7, v7, v8
    v_mov_b32 v8, v7
    s_nop 1
    v_permlane32_swap_b32 v7, v8
    s_nop 0
    v_max_f32 v7, v7, v8
    v_sub_f32 v9, v5, v7
    v_mul_f32 v10, s82, v7
    v_mul_f32 v9, s82, v9
    v_mov_b32 v5, v7
    v_fma_f32 v40, v40, s82, -v10
    v_fma_f32 v41, v41, s82, -v10
    v_fma_f32 v42, v42, s82, -v10
    v_fma_f32 v43, v43, s82, -v10
    v_exp_f32 v9, v9
    v_exp_f32 v40, v40
    v_exp_f32 v41, v41
    v_exp_f32 v42, v42
    v_exp_f32 v43, v43
    s_nop 0
    v_add_f32 v11, v40, v41
    v_add_f32 v12, v42, v43
    v_cvt_pk_bf16_f32 v36, v40, v40
    v_cvt_pk_bf16_f32 v37, v41, v41
    v_cvt_pk_bf16_f32 v38, v42, v42
    v_cvt_pk_bf16_f32 v39, v43, v43
    v_add_f32 v11, v11, v12
    v_fma_f32 v6, v6, v9, v11
    v_and_b32 v28, v3, v36
    v_and_b32 v29, v4, v36
    v_and_b32 v30, v3, v37
    v_and_b32 v31, v4, v37
    v_and_b32 v32, v3, v38
    v_and_b32 v33, v4, v38
    v_and_b32 v34, v3, v39
    v_and_b32 v35, v4, v39
    v_mul_f32_dpp v20, v9, v20 quad_perm:[0,0,0,0] row_mask:0xf bank_mask:0xf
    v_mul_f32_dpp v24, v9, v24 quad_perm:[0,0,0,0] row_mask:0xf bank_mask:0xf
    v_mul_f32_dpp v21, v9, v21 quad_perm:[1,1,1,1] row_mask:0xf bank_mask:0xf
    v_mul_f32_dpp v25, v9, v25 quad_perm:[1,1,1,1] row_mask:0xf bank_mask:0xf
    v_mul_f32_dpp v22, v9, v22 quad_perm:[2,2,2,2] row_mask:0xf bank_mask:0xf
    v_mul_f32_dpp v26, v9, v26 quad_perm:[2,2,2,2] row_mask:0xf bank_mask:0xf
    v_mul_f32_dpp v23, v9, v23 quad_perm:[3,3,3,3] row_mask:0xf bank_mask:0xf
    v_mul_f32_dpp v27, v9, v27 quad_perm:[3,3,3,3] row_mask:0xf bank_mask:0xf
    s_waitcnt vmcnt(56)
    s_nop 0
    v_mfma_f32_16x16x16_bf16 v[20:23], v[28:29], a[112:113], v[20:23]
    v_mfma_f32_16x16x16_bf16 v[24:27], v[28:29], a[114:115], v[24:27]
    v_mfma_f32_16x16x16_bf16 v[20:23], v[30:31], a[116:117], v[20:23]
    v_mfma_f32_16x16x16_bf16 v[24:27], v[30:31], a[118:119], v[24:27]
    v_mfma_f32_16x16x16_bf16 v[20:23], v[32:33], a[120:121], v[20:23]
    v_mfma_f32_16x16x16_bf16 v[24:27], v[32:33], a[122:123], v[24:27]
    v_mfma_f32_16x16x16_bf16 v[20:23], v[34:35], a[124:125], v[20:23]
    v_mfma_f32_16x16x16_bf16 v[24:27], v[34:35], a[126:127], v[24:27]
    s_waitcnt lgkmcnt(0)
    v_readfirstlane_b32 s63, v46
    s_waitcnt vmcnt(32)
    s_lshl_b32 s13, s63, 12
    s_add_u32 s12, s15, s13
    s_cmp_lt_u32 s63, s14
    s_cselect_b32 s12, s12, 0x7ff00000
    buffer_load_dwordx4 a[96:99], v1, s[40:43], s12 offen offset:0 nt
    buffer_load_dwordx4 a[100:103], v1, s[40:43], s12 offen offset:64 nt
    buffer_load_dwordx4 a[104:107], v1, s[40:43], s12 offen offset:128 nt
    buffer_load_dwordx4 a[108:111], v1, s[40:43], s12 offen offset:192 nt
    buffer_load_dwordx4 a[112:115], v2, s[44:47], s12 offen offset:0 nt
    buffer_load_dwordx4 a[116:119], v2, s[44:47], s12 offen offset:1024 nt
    buffer_load_dwordx4 a[120:123], v2, s[44:47], s12 offen offset:2048 nt
    buffer_load_dwordx4 a[124:127], v2, s[44:47], s12 offen offset:3072 nt
    s_mov_b64 exec, 1
    ds_add_rtn_u32 v46, v44, v45
    s_mov_b64 exec, -1
    s_cmp_ge_u32 s64, s14
    s_cbranch_scc1 L_sdone
    s_waitcnt vmcnt(60)
    v_mfma_f32_16x16x32_bf16 v[16:19], a[128:131], v[48:51], 0
    v_mfma_f32_16x16x32_bf16 v[16:19], a[132:135], v[52:55], v[16:19]
    v_mfma_f32_16x16x32_bf16 v[16:19], a[136:139], v[56:59], v[16:19]
    v_mfma_f32_16x16x32_bf16 v[16:19], a[140:143], v[60:63], v[16:19]
    s_nop 7
    v_cvt_pk_bf16_f32 v36, v16, v17
    v_cvt_pk_bf16_f32 v37, v18, v19
    v_lshlrev_b32 v40, 16, v36
    v_and_b32 v41, 0xffff0000, v36
    v_lshlrev_b32 v42, 16, v37
    v_and_b32 v43, 0xffff0000, v37
    v_mul_f32 v40, s84, v40
    v_mul_f32 v41, s84, v41
    v_mul_f32 v42, s84, v42
    v_mul_f32 v43, s84, v43
    v_cvt_pk_bf16_f32 v36, v40, v41
    v_cvt_pk_bf16_f32 v37, v42, v43
    v_lshlrev_b32 v40, 16, v36
    v_and_b32 v41, 0xffff0000, v36
    v_lshlrev_b32 v42, 16, v37
    v_and_b32 v43, 0xffff0000, v37
    v_max3_f32 v7, v40, v41, v42
    v_max3_f32 v7, v7, v43, v5
    v_mov_b32 v8, v7
    s_nop 1
    v_permlane16_swap_b32 v7, v8
    s_nop 0
    v_max_f32 v7, v7, v8
    v_mov_b32 v8, v7
    s_nop 1
    v_permlane32_swap_b32 v7, v8
    s_nop 0
    v_max_f32 v7, v7, v8
    v_sub_f32 v9, v5, v7
    v_mul_f32 v10, s82, v7
    v_mul_f32 v9, s82, v9
    v_mov_b32 v5, v7
    v_fma_f32 v40, v40, s82, -v10
    v_fma_f32 v41, v41, s82, -v10
    v_fma_f32 v42, v42, s82, -v10
    v_fma_f32 v43, v43, s82, -v10
    v_exp_f32 v9, v9
    v_exp_f32 v40, v40
    v_exp_f32 v41, v41
    v_exp_f32 v42, v42
    v_exp_f32 v43, v43
    s_nop 0
    v_add_f32 v11, v40, v41
    v_add_f32 v12, v42, v43
    v_cvt_pk_bf16_f32 v36, v40, v40
    v_cvt_pk_bf16_f32 v37, v41, v41
    v_cvt_pk_bf16_f32 v38, v42, v42
    v_cvt_pk_bf16_f32 v39, v43, v43
    v_add_f32 v11, v11, v12
    v_fma_f32 v6, v6, v9, v11
    v_and_b32 v28, v3, v36
    v_and_b32 v29, v4, v36
    v_and_b32 v30, v3, v37
    v_and_b32 v31, v4, v37
    v_and_b32 v32, v3, v38
    v_and_b32 v33, v4, v38
    v_and_b32 v34, v3, v39
    v_and_b32 v35, v4, v39
    v_mul_f32_dpp v20, v9, v20 quad_perm:[0,0,0,0] row_mask:0xf bank_mask:0xf
    v_mul_f32_dpp v24, v9, v24 quad_perm:[0,0,0,0] row_mask:0xf bank_mask:0xf
    v_mul_f32_dpp v21, v9, v21 quad_perm:[1,1,1,1] row_mask:0xf bank_mask:0xf
    v_mul_f32_dpp v25, v9, v25 quad_perm:[1,1,1,1] row_mask:0xf bank_mask:0xf
    v_mul_f32_dpp v22, v9, v22 quad_perm:[2,2,2,2] row_mask:0xf bank_mask:0xf
    v_mul_f32_dpp v26, v9, v26 quad_perm:[2,2,2,2] row_mask:0xf bank_mask:0xf
    v_mul_f32_dpp v23, v9, v23 quad_perm:[3,3,3,3] row_mask:0xf bank_mask:0xf
    v_mul_f32_dpp v27, v9, v27 quad_perm:[3,3,3,3] row_mask:0xf bank_mask:0xf
    s_waitcnt vmcnt(56)
    s_nop 0
    v_mfma_f32_16x16x16_bf16 v[20:23], v[28:29], a[144:145], v[20:23]
    v_mfma_f32_16x16x16_bf16 v[24:27], v[28:29], a[146:147], v[24:27]
    v_mfma_f32_16x16x16_bf16 v[20:23], v[30:31], a[148:149], v[20:23]
    v_mfma_f32_16x16x16_bf16 v[24:27], v[30:31], a[150:151], v[24:27]
    v_mfma_f32_16x16x16_bf16 v[20:23], v[32:33], a[152:153], v[20:23]
    v_mfma_f32_16x16x16_bf16 v[24:27], v[32:33], a[154:155], v[24:27]
    v_mfma_f32_16x16x16_bf16 v[20:23], v[34:35], a[156:157], v[20:23]
    v_mfma_f32_16x16x16_bf16 v[24:27], v[34:35], a[158:159], v[24:27]
    s_waitcnt lgkmcnt(0)
    v_readfirstlane_b32 s64, v46
    s_waitcnt vmcnt(32)
    s_lshl_b32 s13, s64, 12
    s_add_u32 s12, s15, s13
    s_cmp_lt_u32 s64, s14
    s_cselect_b32 s12, s12, 0x7ff00000
    buffer_load_dwordx4 a[128:131], v1, s[40:43], s12 offen offset:0 nt
    buffer_load_dwordx4 a[132:135], v1, s[40:43], s12 offen offset:64 nt
    buffer_load_dwordx4 a[136:139], v1, s[40:43], s12 offen offset:128 nt
    buffer_load_dwordx4 a[140:143], v1, s[40:43], s12 offen offset:192 nt
    buffer_load_dwordx4 a[144:147], v2, s[44:47], s12 offen offset:0 nt
    buffer_load_dwordx4 a[148:151], v2, s[44:47], s12 offen offset:1024 nt
    buffer_load_dwordx4 a[152:155], v2, s[44:47], s12 offen offset:2048 nt
    buffer_load_dwordx4 a[156:159], v2, s[44:47], s12 offen offset:3072 nt
    s_mov_b64 exec, 1
    ds_add_rtn_u32 v46, v44, v45
    s_mov_b64 exec, -1
    s_cmp_ge_u32 s65, s14
    s_cbranch_scc1 L_sdone
    s_waitcnt vmcnt(60)
    v_mfma_f32_16x16x32_bf16 v[16:19], a[160:163], v[48:51], 0
    v_mfma_f32_16x16x32_bf16 v[16:19], a[164:167], v[52:55], v[16:19]
    v_mfma_f32_16x16x32_bf16 v[16:19], a[168:171], v[56:59], v[16:19]
    v_mfma_f32_16x16x32_bf16 v[16:19], a[172:175], v[60:63], v[16:19]
    s_nop 7
    v_cvt_pk_bf16_f32 v36, v16, v17
    v_cvt_pk_bf16_f32 v37, v18, v19
    v_lshlrev_b32 v40, 16, v36
    v_and_b32 v41, 0xffff0000, v36
    v_lshlrev_b32 v42, 16, v37
    v_and_b32 v43, 0xffff0000, v37
    v_mul_f32 v40, s84, v40
    v_mul_f32 v41, s84, v41
    v_mul_f32 v42, s84, v42
    v_mul_f32 v43, s84, v43
    v_cvt_pk_bf16_f32 v36, v40, v41
    v_cvt_pk_bf16_f32 v37, v42, v43
    v_lshlrev_b32 v40, 16, v36
    v_and_b32 v41, 0xffff0000, v36
    v_lshlrev_b32 v42, 16, v37
    v_and_b32 v43, 0xffff0000, v37
    v_max3_f32 v7, v40, v41, v42
    v_max3_f32 v7, v7, v43, v5
    v_mov_b32 v8, v7
    s_nop 1
    v_permlane16_swap_b32 v7, v8
    s_nop 0
    v_max_f32 v7, v7, v8
    v_mov_b32 v8, v7
    s_nop 1
    v_permlane32_swap_b32 v7, v8
    s_nop 0
    v_max_f32 v7, v7, v8
    v_sub_f32 v9, v5, v7
    v_mul_f32 v10, s82, v7
    v_mul_f32 v9, s82, v9
    v_mov_b32 v5, v7
    v_fma_f32 v40, v40, s82, -v10
    v_fma_f32 v41, v41, s82, -v10
    v_fma_f32 v42, v42, s82, -v10
    v_fma_f32 v43, v43, s82, -v10
    v_exp_f32 v9, v9
    v_exp_f32 v40, v40
    v_exp_f32 v41, v41
    v_exp_f32 v42, v42
    v_exp_f32 v43, v43
    s_nop 0
    v_add_f32 v11, v40, v41
    v_add_f32 v12, v42, v43
    v_cvt_pk_bf16_f32 v36, v40, v40
    v_cvt_pk_bf16_f32 v37, v41, v41
    v_cvt_pk_bf16_f32 v38, v42, v42
    v_cvt_pk_bf16_f32 v39, v43, v43
    v_add_f32 v11, v11, v12
    v_fma_f32 v6, v6, v9, v11
    v_and_b32 v28, v3, v36
    v_and_b32 v29, v4, v36
    v_and_b32 v30, v3, v37
    v_and_b32 v31, v4, v37
    v_and_b32 v32, v3, v38
    v_and_b32 v33, v4, v38
    v_and_b32 v34, v3, v39
    v_and_b32 v35, v4, v39
    v_mul_f32_dpp v20, v9, v20 quad_perm:[0,0,0,0] row_mask:0xf bank_mask:0xf
    v_mul_f32_dpp v24, v9, v24 quad_perm:[0,0,0,0] row_mask:0xf bank_mask:0xf
    v_mul_f32_dpp v21, v9, v21 quad_perm:[1,1,1,1] row_mask:0xf bank_mask:0xf
    v_mul_f32_dpp v25, v9, v25 quad_perm:[1,1,1,1] row_mask:0xf bank_mask:0xf
    v_mul_f32_dpp v22, v9, v22 quad_perm:[2,2,2,2] row_mask:0xf bank_mask:0xf
    v_mul_f32_dpp v26, v9, v26 quad_perm:[2,2,2,2] row_mask:0xf bank_mask:0xf
    v_mul_f32_dpp v23, v9, v23 quad_perm:[3,3,3,3] row_mask:0xf bank_mask:0xf
    v_mul_f32_dpp v27, v9, v27 quad_perm:[3,3,3,3] row_mask:0xf bank_mask:0xf
    s_waitcnt vmcnt(56)
    s_nop 0
    v_mfma_f32_16x16x16_bf16 v[20:23], v[28:29], a[176:177], v[20:23]
    v_mfma_f32_16x16x16_bf16 v[24:27], v[28:29], a[178:179], v[24:27]
    v_mfma_f32_16x16x16_bf16 v[20:23], v[30:31], a[180:181], v[20:23]
    v_mfma_f32_16x16x16_bf16 v[24:27], v[30:31], a[182:183], v[24:27]
    v_mfma_f32_16x16x16_bf16 v[20:23], v[32:33], a[184:185], v[20:23]
    v_mfma_f32_16x16x16_bf16 v[24:27], v[32:33], a[186:187], v[24:27]
    v_mfma_f32_16x16x16_bf16 v[20:23], v[34:35], a[188:189], v[20:23]
    v_mfma_f32_16x16x16_bf16 v[24:27], v[34:35], a[190:191], v[24:27]
    s_waitcnt lgkmcnt(0)
    v_readfirstlane_b32 s65, v46
    s_waitcnt vmcnt(32)
    s_lshl_b32 s13, s65, 12
    s_add_u32 s12, s15, s13
    s_cmp_lt_u32 s65, s14
    s_cselect_b32 s12, s12, 0x7ff00000
    buffer_load_dwordx4 a[160:163], v1, s[40:43], s12 offen offset:0 nt
    buffer_load_dwordx4 a[164:167], v1, s[40:43], s12 offen offset:64 nt
    buffer_load_dwordx4 a[168:171], v1, s[40:43], s12 offen offset:128 nt
    buffer_load_dwordx4 a[172:175], v1, s[40:43], s12 offen offset:192 nt
    buffer_load_dwordx4 a[176:179], v2, s[44:47], s12 offen offset:0 nt
    buffer_load_dwordx4 a[180:183], v2, s[44:47], s12 offen offset:1024 nt
    buffer_load_dwordx4 a[184:187], v2, s[44:47], s12 offen offset:2048 nt
    buffer_load_dwordx4 a[188:191], v2, s[44:47], s12 offen offset:3072 nt
    s_mov_b64 exec, 1
    ds_add_rtn_u32 v46, v44, v45
    s_mov_b64 exec, -1
    s_cmp_ge_u32 s66, s14
    s_cbranch_scc1 L_sdone
    s_waitcnt vmcnt(60)
    v_mfma_f32_16x16x32_bf16 v[16:19], a[192:195], v[48:51], 0
    v_mfma_f32_16x16x32_bf16 v[16:19], a[196:199], v[52:55], v[16:19]
    v_mfma_f32_16x16x32_bf16 v[16:19], a[200:203], v[56:59], v[16:19]
    v_mfma_f32_16x16x32_bf16 v[16:19], a[204:207], v[60:63], v[16:19]
    s_nop 7
    v_cvt_pk_bf16_f32 v36, v16, v17
    v_cvt_pk_bf16_f32 v37, v18, v19
    v_lshlrev_b32 v40, 16, v36
    v_and_b32 v41, 0xffff0000, v36
    v_lshlrev_b32 v42, 16, v37
    v_and_b32 v43, 0xffff0000, v37
    v_mul_f32 v40, s84, v40
    v_mul_f32 v41, s84, v41
    v_mul_f32 v42, s84, v42
    v_mul_f32 v43, s84, v43
    v_cvt_pk_bf16_f32 v36, v40, v41
    v_cvt_pk_bf16_f32 v37, v42, v43
    v_lshlrev_b32 v40, 16, v36
    v_and_b32 v41, 0xffff0000, v36
    v_lshlrev_b32 v42, 16, v37
    v_and_b32 v43, 0xffff0000, v37
    v_max3_f32 v7, v40, v41, v42
    v_max3_f32 v7, v7, v43, v5
    v_mov_b32 v8, v7
    s_nop 1
    v_permlane16_swap_b32 v7, v8
    s_nop 0
    v_max_f32 v7, v7, v8
    v_mov_b32 v8, v7
    s_nop 1
    v_permlane32_swap_b32 v7, v8
    s_nop 0
    v_max_f32 v7, v7, v8
    v_sub_f32 v9, v5, v7
    v_mul_f32 v10, s82, v7
    v_mul_f32 v9, s82, v9
    v_mov_b32 v5, v7
    v_fma_f32 v40, v40, s82, -v10
    v_fma_f32 v41, v41, s82, -v10
    v_fma_f32 v42, v42, s82, -v10
    v_fma_f32 v43, v43, s82, -v10
    v_exp_f32 v9, v9
    v_exp_f32 v40, v40
    v_exp_f32 v41, v41
    v_exp_f32 v42, v42
    v_exp_f32 v43, v43
    s_nop 0
    v_add_f32 v11, v40, v41
    v_add_f32 v12, v42, v43
    v_cvt_pk_bf16_f32 v36, v40, v40
    v_cvt_pk_bf16_f32 v37, v41, v41
    v_cvt_pk_bf16_f32 v38, v42, v42
    v_cvt_pk_bf16_f32 v39, v43, v43
    v_add_f32 v11, v11, v12
    v_fma_f32 v6, v6, v9, v11
    v_and_b32 v28, v3, v36
    v_and_b32 v29, v4, v36
    v_and_b32 v30, v3, v37
    v_and_b32 v31, v4, v37
    v_and_b32 v32, v3, v38
    v_and_b32 v33, v4, v38
    v_and_b32 v34, v3, v39
    v_and_b32 v35, v4, v39
    v_mul_f32_dpp v20, v9, v20 quad_perm:[0,0,0,0] row_mask:0xf bank_mask:0xf
    v_mul_f32_dpp v24, v9, v24 quad_perm:[0,0,0,0] row_mask:0xf bank_mask:0xf
    v_mul_f32_dpp v21, v9, v21 quad_perm:[1,1,1,1] row_mask:0xf bank_mask:0xf
    v_mul_f32_dpp v25, v9, v25 quad_perm:[1,1,1,1] row_mask:0xf bank_mask:0xf
    v_mul_f32_dpp v22, v9, v22 quad_perm:[2,2,2,2] row_mask:0xf bank_mask:0xf
    v_mul_f32_dpp v26, v9, v26 quad_perm:[2,2,2,2] row_mask:0xf bank_mask:0xf
    v_mul_f32_dpp v23, v9, v23 quad_perm:[3,3,3,3] row_mask:0xf bank_mask:0xf
    v_mul_f32_dpp v27, v9, v27 quad_perm:[3,3,3,3] row_mask:0xf bank_mask:0xf
    s_waitcnt vmcnt(56)
    s_nop 0
    v_mfma_f32_16x16x16_bf16 v[20:23], v[28:29], a[208:209], v[20:23]
    v_mfma_f32_16x16x16_bf16 v[24:27], v[28:29], a[210:211], v[24:27]
    v_mfma_f32_16x16x16_bf16 v[20:23], v[30:31], a[212:213], v[20:23]
    v_mfma_f32_16x16x16_bf16 v[24:27], v[30:31], a[214:215], v[24:27]
    v_mfma_f32_16x16x16_bf16 v[20:23], v[32:33], a[216:217], v[20:23]
    v_mfma_f32_16x16x16_bf16 v[24:27], v[32:33], a[218:219], v[24:27]
    v_mfma_f32_16x16x16_bf16 v[20:23], v[34:35], a[220:221], v[20:23]
    v_mfma_f32_16x16x16_bf16 v[24:27], v[34:35], a[222:223], v[24:27]
    s_waitcnt lgkmcnt(0)
    v_readfirstlane_b32 s66, v46
    s_waitcnt vmcnt(32)
    s_lshl_b32 s13, s66, 12
    s_add_u32 s12, s15, s13
    s_cmp_lt_u32 s66, s14
    s_cselect_b32 s12, s12, 0x7ff00000
    buffer_load_dwordx4 a[192:195], v1, s[40:43], s12 offen offset:0 nt
    buffer_load_dwordx4 a[196:199], v1, s[40:43], s12 offen offset:64 nt
    buffer_load_dwordx4 a[200:203], v1, s[40:43], s12 offen offset:128 nt
    buffer_load_dwordx4 a[204:207], v1, s[40:43], s12 offen offset:192 nt
    buffer_load_dwordx4 a[208:211], v2, s[44:47], s12 offen offset:0 nt
    buffer_load_dwordx4 a[212:215], v2, s[44:47], s12 offen offset:1024 nt
    buffer_load_dwordx4 a[216:219], v2, s[44:47], s12 offen offset:2048 nt
    buffer_load_dwordx4 a[220:223], v2, s[44:47], s12 offen offset:3072 nt
    s_mov_b64 exec, 1
    ds_add_rtn_u32 v46, v44, v45
    s_mov_b64 exec, -1
    s_cmp_ge_u32 s67, s14
    s_cbranch_scc1 L_sdone
    s_waitcnt vmcnt(60)
    v_mfma_f32_16x16x32_bf16 v[16:19], a[224:227], v[48:51], 0
    v_mfma_f32_16x16x32_bf16 v[16:19], a[228:231], v[52:55], v[16:19]
    v_mfma_f32_16x16x32_bf16 v[16:19], a[232:235], v[56:59], v[16:19]
    v_mfma_f32_16x16x32_bf16 v[16:19], a[236:239], v[60:63], v[16:19]
    s_nop 7
    v_cvt_pk_bf16_f32 v36, v16, v17
    v_cvt_pk_bf16_f32 v37, v18, v19
    v_lshlrev_b32 v40, 16, v36
    v_and_b32 v41, 0xffff0000, v36
    v_lshlrev_b32 v42, 16, v37
    v_and_b32 v43, 0xffff0000, v37
    v_mul_f32 v40, s84, v40
    v_mul_f32 v41, s84, v41
    v_mul_f32 v42, s84, v42
    v_mul_f32 v43, s84, v43
    v_cvt_pk_bf16_f32 v36, v40, v41
    v_cvt_pk_bf16_f32 v37, v42, v43
    v_lshlrev_b32 v40, 16, v36
    v_and_b32 v41, 0xffff0000, v36
    v_lshlrev_b32 v42, 16, v37
    v_and_b32 v43, 0xffff0000, v37
    v_max3_f32 v7, v40, v41, v42
    v_max3_f32 v7, v7, v43, v5
    v_mov_b32 v8, v7
    s_nop 1
    v_permlane16_swap_b32 v7, v8
    s_nop 0
    v_max_f32 v7, v7, v8
    v_mov_b32 v8, v7
    s_nop 1
    v_permlane32_swap_b32 v7, v8
    s_nop 0
    v_max_f32 v7, v7, v8
    v_sub_f32 v9, v5, v7
    v_mul_f32 v10, s82, v7
    v_mul_f32 v9, s82, v9
    v_mov_b32 v5, v7
    v_fma_f32 v40, v40, s82, -v10
    v_fma_f32 v41, v41, s82, -v10
    v_fma_f32 v42, v42, s82, -v10
    v_fma_f32 v43, v43, s82, -v10
    v_exp_f32 v9, v9
    v_exp_f32 v40, v40
    v_exp_f32 v41, v41
    v_exp_f32 v42, v42
    v_exp_f32 v43, v43
    s_nop 0
    v_add_f32 v11, v40, v41
    v_add_f32 v12, v42, v43
    v_cvt_pk_bf16_f32 v36, v40, v40
    v_cvt_pk_bf16_f32 v37, v41, v41
    v_cvt_pk_bf16_f32 v38, v42, v42
    v_cvt_pk_bf16_f32 v39, v43, v43
    v_add_f32 v11, v11, v12
    v_fma_f32 v6, v6, v9, v11
    v_and_b32 v28, v3, v36
    v_and_b32 v29, v4, v36
    v_and_b32 v30, v3, v37
    v_and_b32 v31, v4, v37
    v_and_b32 v32, v3, v38
    v_and_b32 v33, v4, v38
    v_and_b32 v34, v3, v39
    v_and_b32 v35, v4, v39
    v_mul_f32_dpp v20, v9, v20 quad_perm:[0,0,0,0] row_mask:0xf bank_mask:0xf
    v_mul_f32_dpp v24, v9, v24 quad_perm:[0,0,0,0] row_mask:0xf bank_mask:0xf
    v_mul_f32_dpp v21, v9, v21 quad_perm:[1,1,1,1] row_mask:0xf bank_mask:0xf
    v_mul_f32_dpp v25, v9, v25 quad_perm:[1,1,1,1] row_mask:0xf bank_mask:0xf
    v_mul_f32_dpp v22, v9, v22 quad_perm:[2,2,2,2] row_mask:0xf bank_mask:0xf
    v_mul_f32_dpp v26, v9, v26 quad_perm:[2,2,2,2] row_mask:0xf bank_mask:0xf
    v_mul_f32_dpp v23, v9, v23 quad_perm:[3,3,3,3] row_mask:0xf bank_mask:0xf
    v_mul_f32_dpp v27, v9, v27 quad_perm:[3,3,3,3] row_mask:0xf bank_mask:0xf
    s_waitcnt vmcnt(56)
    s_nop 0
    v_mfma_f32_16x16x16_bf16 v[20:23], v[28:29], a[240:241], v[20:23]
    v_mfma_f32_16x16x16_bf16 v[24:27], v[28:29], a[242:243], v[24:27]
    v_mfma_f32_16x16x16_bf16 v[20:23], v[30:31], a[244:245], v[20:23]
    v_mfma_f32_16x16x16_bf16 v[24:27], v[30:31], a[246:247], v[24:27]
    v_mfma_f32_16x16x16_bf16 v[20:23], v[32:33], a[248:249], v[20:23]
    v_mfma_f32_16x16x16_bf16 v[24:27], v[32:33], a[250:251], v[24:27]
    v_mfma_f32_16x16x16_bf16 v[20:23], v[34:35], a[252:253], v[20:23]
    v_mfma_f32_16x16x16_bf16 v[24:27], v[34:35], a[254:255], v[24:27]
    s_waitcnt lgkmcnt(0)
    v_readfirstlane_b32 s67, v46
    s_waitcnt vmcnt(32)
    s_lshl_b32 s13, s67, 12
    s_add_u32 s12, s15, s13
    s_cmp_lt_u32 s67, s14
    s_cselect_b32 s12, s12, 0x7ff00000
    buffer_load_dwordx4 a[224:227], v1, s[40:43], s12 offen offset:0 nt
    buffer_load_dwordx4 a[228:231], v1, s[40:43], s12 offen offset:64 nt
    buffer_load_dwordx4 a[232:235], v1, s[40:43], s12 offen offset:128 nt
    buffer_load_dwordx4 a[236:239], v1, s[40:43], s12 offen offset:192 nt
    buffer_load_dwordx4 a[240:243], v2, s[44:47], s12 offen offset:0 nt
    buffer_load_dwordx4 a[244:247], v2, s[44:47], s12 offen offset:1024 nt
    buffer_load_dwordx4 a[248:251], v2, s[44:47], s12 offen offset:2048 nt
    buffer_load_dwordx4 a[252:255], v2, s[44:47], s12 offen offset:3072 nt
    s_mov_b64 exec, 1
    ds_add_rtn_u32 v46, v44, v45
    s_mov_b64 exec, -1
    s_branch L_sloop
L_sdone:
    v_mov_b32 v8, v6
    s_nop 1
    v_permlane16_swap_b32 v6, v8
    s_nop 0
    v_add_f32 v6, v6, v8
    v_mov_b32 v8, v6
    s_nop 1
    v_permlane32_swap_b32 v6, v8
    s_nop 0
    v_add_f32 v6, v6, v8
    s_nop 7
    ds_write_b32 v14, v20 offset:4096
    ds_write_b32 v14, v24 offset:4112
    ds_write_b32 v14, v21 offset:4608
    ds_write_b32 v14, v25 offset:4624
    ds_write_b32 v14, v22 offset:5120
    ds_write_b32 v14, v26 offset:5136
    ds_write_b32 v14, v23 offset:5632
    ds_write_b32 v14, v27 offset:5648
    v_mov_b32 v8, v5
    v_mov_b32 v9, v6
    ds_write_b64 v15, v[8:9] offset:12288
    s_waitcnt lgkmcnt(0)
    s_barrier
    s_endpgm
L_helper:
    s_setprio 3
    s_memrealtime s[88:89]
    s_mov_b32 s80, 0x05040100
    s_mov_b32 s81, 0x07060302
    s_mov_b32 s86, 0x00010001
    s_mov_b32 s87, 0x00010001
    s_mov_b32 s76, 0x00ff00ff
    s_mov_b32 s77, 0x00ff00ff
    v_lshlrev_b32 v1, 4, v0
    v_lshrrev_b32 v2, 4, v0
    v_lshrrev_b32 v3, 1, v2
    v_and_b32 v14, 1, v2
    v_mov_b32 v15, 0
    v_lshrrev_b32 v50, 3, v0
    v_and_b32 v51, 7, v0
    v_lshlrev_b32 v62, 4, v51
    v_mov_b32 v58, 0
    s_waitcnt lgkmcnt(0)
    s_mov_b32 s40, s16
    s_and_b32 s41, s17, 0xffff
    s_mov_b32 s42, 2048
    s_mov_b32 s43, 0x20000
    s_mov_b32 s44, s22
    s_and_b32 s45, s23, 0xffff
    s_mov_b32 s46, 4194304
    s_mov_b32 s47, 0x20000
    s_mov_b32 s48, s38
    s_and_b32 s49, s39, 0xffff
    s_mov_b32 s50, 4194304
    s_mov_b32 s51, 0x20000
    s_mov_b32 s52, s36
    s_and_b32 s53, s37, 0xffff
    s_mov_b32 s54, 256
    s_mov_b32 s55, 0x20000
    s_or_b32 s88, s88, 1
    s_cmp_lg_u32 s2, 0
    s_cbranch_scc1 L_nonz
    v_mov_b32 v12, s88
    v_mov_b32 v13, s89
    s_mov_b64 exec, 1
    buffer_store_dwordx2 v[12:13], v15, s[52:55], 0 offen sc1
    s_mov_b64 exec, -1
L_nonz:
    buffer_load_dwordx4 v[4:7], v1, s[40:43], 0 offen
    buffer_load_dwordx4 v[8:11], v1, s[40:43], 0 offen offset:1024
    s_cmp_ge_u32 s6, 8
    s_cbranch_scc1 L_t1
    s_mov_b32 s9, 0
    s_mov_b32 s10, s6
    s_mov_b32 s11, s7
    s_mov_b32 s85, 0
    s_lshl_b32 s12, s4, 10
    s_lshl_b32 s13, s10, 7
    s_add_u32 s12, s12, s13
    s_lshl_b32 s13, s11, 21
    s_add_u32 s12, s12, s13
    v_lshl_add_u32 v12, v50, 14, v62
    v_add_u32 v12, s12, v12
    s_mov_b32 s14, 0
    buffer_load_dwordx4 v[64:67], v12, s[44:47], s14 offen nt
    s_add_u32 s14, s14, 8192
    buffer_load_dwordx4 v[68:71], v12, s[44:47], s14 offen nt
    s_add_u32 s14, s14, 122880
    buffer_load_dwordx4 v[72:75], v12, s[44:47], s14 offen nt
    s_add_u32 s14, s14, 8192
    buffer_load_dwordx4 v[76:79], v12, s[44:47], s14 offen nt
    s_add_u32 s14, s14, 122880
    buffer_load_dwordx4 v[80:83], v12, s[44:47], s14 offen nt
    s_add_u32 s14, s14, 8192
    buffer_load_dwordx4 v[84:87], v12, s[44:47], s14 offen nt
    s_add_u32 s14, s14, 122880
    buffer_load_dwordx4 v[88:91], v12, s[44:47], s14 offen nt
    s_add_u32 s14, s14, 8192
    buffer_load_dwordx4 v[92:95], v12, s[44:47], s14 offen nt
    s_add_u32 s14, s14, 122880
    buffer_load_dwordx4 v[96:99], v12, s[44:47], s14 offen nt
    s_add_u32 s14, s14, 8192
    buffer_load_dwordx4 v[100:103], v12, s[44:47], s14 offen nt
    s_add_u32 s14, s14, 122880
    buffer_load_dwordx4 v[104:107], v12, s[44:47], s14 offen nt
    s_add_u32 s14, s14, 8192
    buffer_load_dwordx4 v[108:111], v12, s[44:47], s14 offen nt
    s_add_u32 s14, s14, 122880
    buffer_load_dwordx4 v[112:115], v12, s[44:47], s14 offen nt
    s_add_u32 s14, s14, 8192
    buffer_load_dwordx4 v[116:119], v12, s[44:47], s14 offen nt
    s_add_u32 s14, s14, 122880
    buffer_load_dwordx4 v[120:123], v12, s[44:47], s14 offen nt
    s_add_u32 s14, s14, 8192
    buffer_load_dwordx4 v[124:127], v12, s[44:47], s14 offen nt
    s_add_u32 s14, s14, 122880
    buffer_load_dwordx4 v[128:131], v12, s[44:47], s14 offen nt
    s_add_u32 s14, s14, 8192
    buffer_load_dwordx4 v[132:135], v12, s[44:47], s14 offen nt
    s_add_u32 s14, s14, 122880
    buffer_load_dwordx4 v[136:139], v12, s[44:47], s14 offen nt
    s_add_u32 s14, s14, 8192
    buffer_load_dwordx4 v[140:143], v12, s[44:47], s14 offen nt
    s_add_u32 s14, s14, 122880
    buffer_load_dwordx4 v[144:147], v12, s[44:47], s14 offen nt
    s_add_u32 s14, s14, 8192
    buffer_load_dwordx4 v[148:151], v12, s[44:47], s14 offen nt
    s_add_u32 s14, s14, 122880
    buffer_load_dwordx4 v[152:155], v12, s[44:47], s14 offen nt
    s_add_u32 s14, s14, 8192
    buffer_load_dwordx4 v[156:159], v12, s[44:47], s14 offen nt
    s_add_u32 s14, s14, 122880
    buffer_load_dwordx4 v[160:163], v12, s[44:47], s14 offen nt
    s_add_u32 s14, s14, 8192
    buffer_load_dwordx4 v[164:167], v12, s[44:47], s14 offen nt
    s_add_u32 s14, s14, 122880
    buffer_load_dwordx4 v[168:171], v12, s[44:47], s14 offen nt
    s_add_u32 s14, s14, 8192
    buffer_load_dwordx4 v[172:175], v12, s[44:47], s14 offen nt
    s_add_u32 s14, s14, 122880
    buffer_load_dwordx4 v[176:179], v12, s[44:47], s14 offen nt
    s_add_u32 s14, s14, 8192
    buffer_load_dwordx4 v[180:183], v12, s[44:47], s14 offen nt
    s_add_u32 s14, s14, 122880
    buffer_load_dwordx4 v[184:187], v12, s[44:47], s14 offen nt
    s_add_u32 s14, s14, 8192
    buffer_load_dwordx4 v[188:191], v12, s[44:47], s14 offen nt
    s_branch L_t2
L_t1:
    s_lshl_b32 s10, s8, 3
    s_add_u32 s10, s10, s6
    s_sub_u32 s10, s10, 8
    s_mov_b32 s9, 2
    s_mov_b32 s11, 0
    s_mov_b32 s85, 0
    s_cmp_ge_u32 s10, 112
    s_cbranch_scc1 L_t2
    s_mov_b32 s9, 1
    s_cmp_ge_u32 s10, 56
    s_cselect_b32 s85, 1, 0
    s_cselect_b32 s12, s30, s28
    s_cselect_b32 s13, s31, s29
    s_mov_b32 s68, s12
    s_and_b32 s69, s13, 0xffff
    s_mov_b32 s70, 1835008
    s_mov_b32 s71, 0x20000
    s_mul_i32 s12, s85, 56
    s_sub_u32 s10, s10, s12
    s_and_b32 s11, s10, 1
    s_lshr_b32 s10, s10, 1
    s_mul_i32 s12, s11, 917504
    s_lshl_b32 s13, s10, 7
    s_add_u32 s12, s12, s13
    s_mov_b32 s14, 7168
    v_mul_lo_u32 v12, v50, s14
    v_add3_u32 v12, v12, v62, s12
    s_mov_b32 s14, 0
    buffer_load_dwordx4 v[64:67], v12, s[68:71], s14 offen offset:0 nt
    buffer_load_dwordx4 v[68:71], v12, s[68:71], s14 offen offset:3584 nt
    s_add_u32 s14, s14, 57344
    buffer_load_dwordx4 v[72:75], v12, s[68:71], s14 offen offset:0 nt
    buffer_load_dwordx4 v[76:79], v12, s[68:71], s14 offen offset:3584 nt
    s_add_u32 s14, s14, 57344
    buffer_load_dwordx4 v[80:83], v12, s[68:71], s14 offen offset:0 nt
    buffer_load_dwordx4 v[84:87], v12, s[68:71], s14 offen offset:3584 nt
    s_add_u32 s14, s14, 57344
    buffer_load_dwordx4 v[88:91], v12, s[68:71], s14 offen offset:0 nt
    buffer_load_dwordx4 v[92:95], v12, s[68:71], s14 offen offset:3584 nt
    s_add_u32 s14, s14, 57344
    buffer_load_dwordx4 v[96:99], v12, s[68:71], s14 offen offset:0 nt
    buffer_load_dwordx4 v[100:103], v12, s[68:71], s14 offen offset:3584 nt
    s_add_u32 s14, s14, 57344
    buffer_load_dwordx4 v[104:107], v12, s[68:71], s14 offen offset:0 nt
    buffer_load_dwordx4 v[108:111], v12, s[68:71], s14 offen offset:3584 nt
    s_add_u32 s14, s14, 57344
    buffer_load_dwordx4 v[112:115], v12, s[68:71], s14 offen offset:0 nt
    buffer_load_dwordx4 v[116:119], v12, s[68:71], s14 offen offset:3584 nt
    s_add_u32 s14, s14, 57344
    buffer_load_dwordx4 v[120:123], v12, s[68:71], s14 offen offset:0 nt
    buffer_load_dwordx4 v[124:127], v12, s[68:71], s14 offen offset:3584 nt
    s_add_u32 s14, s14, 57344
    buffer_load_dwordx4 v[128:131], v12, s[68:71], s14 offen offset:0 nt
    buffer_load_dwordx4 v[132:135], v12, s[68:71], s14 offen offset:3584 nt
    s_add_u32 s14, s14, 57344
    buffer_load_dwordx4 v[136:139], v12, s[68:71], s14 offen offset:0 nt
    buffer_load_dwordx4 v[140:143], v12, s[68:71], s14 offen offset:3584 nt
    s_add_u32 s14, s14, 57344
    buffer_load_dwordx4 v[144:147], v12, s[68:71], s14 offen offset:0 nt
    buffer_load_dwordx4 v[148:151], v12, s[68:71], s14 offen offset:3584 nt
    s_add_u32 s14, s14, 57344
    buffer_load_dwordx4 v[152:155], v12, s[68:71], s14 offen offset:0 nt
    buffer_load_dwordx4 v[156:159], v12, s[68:71], s14 offen offset:3584 nt
    s_add_u32 s14, s14, 57344
    buffer_load_dwordx4 v[160:163], v12, s[68:71], s14 offen offset:0 nt
    buffer_load_dwordx4 v[164:167], v12, s[68:71], s14 offen offset:3584 nt
    s_add_u32 s14, s14, 57344
    buffer_load_dwordx4 v[168:171], v12, s[68:71], s14 offen offset:0 nt
    buffer_load_dwordx4 v[172:175], v12, s[68:71], s14 offen offset:3584 nt
    s_add_u32 s14, s14, 57344
    buffer_load_dwordx4 v[176:179], v12, s[68:71], s14 offen offset:0 nt
    buffer_load_dwordx4 v[180:183], v12, s[68:71], s14 offen offset:3584 nt
    s_add_u32 s14, s14, 57344
    buffer_load_dwordx4 v[184:187], v12, s[68:71], s14 offen offset:0 nt
    buffer_load_dwordx4 v[188:191], v12, s[68:71], s14 offen offset:3584 nt
L_t2:
    v_mov_b32 v12, 12416
    v_mov_b32 v16, 24
    v_mov_b32 v17, 0
    ds_write_b64 v12, v[16:17]
    s_waitcnt lgkmcnt(0)
    s_barrier
    s_mov_b32 s56, s32
    s_and_b32 s57, s33, 0xffff
    s_mov_b32 s58, 1835008
    s_mov_b32 s59, 0x20000
    s_mov_b32 s60, s24
    s_and_b32 s61, s25, 0xffff
    s_mov_b32 s62, 4194304
    s_mov_b32 s63, 0x20000
    s_mov_b32 s64, s34
    s_and_b32 s65, s35, 0xffff
    s_mov_b32 s66, 2048
    s_mov_b32 s67, 0x20000
    s_cmp_eq_u32 s9, 2
    s_cbranch_scc1 L_xw0
    s_waitcnt vmcnt(32)
    s_branch L_xw1
L_xw0:
    s_waitcnt vmcnt(0)
L_xw1:
    v_lshlrev_b32 v16, 16, v4
    v_and_b32 v17, 0xffff0000, v4
    v_lshlrev_b32 v18, 16, v5
    v_and_b32 v19, 0xffff0000, v5
    v_lshlrev_b32 v20, 16, v6
    v_and_b32 v21, 0xffff0000, v6
    v_lshlrev_b32 v22, 16, v7
    v_and_b32 v23, 0xffff0000, v7
    v_lshlrev_b32 v24, 16, v8
    v_and_b32 v25, 0xffff0000, v8
    v_lshlrev_b32 v26, 16, v9
    v_and_b32 v27, 0xffff0000, v9
    v_lshlrev_b32 v28, 16, v10
    v_and_b32 v29, 0xffff0000, v10
    v_lshlrev_b32 v30, 16, v11
    v_and_b32 v31, 0xffff0000, v11
    v_add_f32 v32, v16, v17
    v_add_f32 v33, v24, v25
    v_add_f32 v32, v32, v18
    v_add_f32 v33, v33, v26
    v_add_f32 v32, v32, v19
    v_add_f32 v33, v33, v27
    v_add_f32 v32, v32, v20
    v_add_f32 v33, v33, v28
    v_add_f32 v32, v32, v21
    v_add_f32 v33, v33, v29
    v_add_f32 v32, v32, v22
    v_add_f32 v33, v33, v30
    v_add_f32 v32, v32, v23
    v_add_f32 v33, v33, v31
    s_nop 1
    v_add_f32_dpp v32, v32, v32 row_ror:8 row_mask:0xf bank_mask:0xf
    v_add_f32_dpp v33, v33, v33 row_ror:8 row_mask:0xf bank_mask:0xf
    s_nop 1
    v_add_f32_dpp v32, v32, v32 row_ror:4 row_mask:0xf bank_mask:0xf
    v_add_f32_dpp v33, v33, v33 row_ror:4 row_mask:0xf bank_mask:0xf
    s_nop 1
    v_add_f32_dpp v32, v32, v32 row_ror:2 row_mask:0xf bank_mask:0xf
    v_add_f32_dpp v33, v33, v33 row_ror:2 row_mask:0xf bank_mask:0xf
    s_nop 1
    v_add_f32_dpp v32, v32, v32 row_ror:1 row_mask:0xf bank_mask:0xf
    v_add_f32_dpp v33, v33, v33 row_ror:1 row_mask:0xf bank_mask:0xf
    v_mov_b32 v34, v32
    v_mov_b32 v35, v33
    s_nop 1
    v_permlane16_swap_b32 v32, v34
    v_permlane16_swap_b32 v33, v35
    s_nop 0
    v_add_f32 v32, v32, v34
    v_add_f32 v33, v33, v35
    v_mov_b32 v34, v32
    v_mov_b32 v35, v33
    s_nop 1
    v_permlane32_swap_b32 v32, v34
    v_permlane32_swap_b32 v33, v35
    s_nop 0
    v_add_f32 v32, v32, v34
    v_add_f32 v33, v33, v35
    v_mul_f32 v32, 989855744, v32
    v_mul_f32 v33, 989855744, v33
    v_mov_b32 v36, 0
    v_mov_b32 v37, 0
    v_sub_f32 v38, v16, v32
    v_sub_f32 v39, v24, v33
    v_fmac_f32 v36, v38, v38
    v_fmac_f32 v37, v39, v39
    v_sub_f32 v38, v17, v32
    v_sub_f32 v39, v25, v33
    v_fmac_f32 v36, v38, v38
    v_fmac_f32 v37, v39, v39
    v_sub_f32 v38, v18, v32
    v_sub_f32 v39, v26, v33
    v_fmac_f32 v36, v38, v38
    v_fmac_f32 v37, v39, v39
    v_sub_f32 v38, v19, v32
    v_sub_f32 v39, v27, v33
    v_fmac_f32 v36, v38, v38
    v_fmac_f32 v37, v39, v39
    v_sub_f32 v38, v20, v32
    v_sub_f32 v39, v28, v33
    v_fmac_f32 v36, v38, v38
    v_fmac_f32 v37, v39, v39
    v_sub_f32 v38, v21, v32
    v_sub_f32 v39, v29, v33
    v_fmac_f32 v36, v38, v38
    v_fmac_f32 v37, v39, v39
    v_sub_f32 v38, v22, v32
    v_sub_f32 v39, v30, v33
    v_fmac_f32 v36, v38, v38
    v_fmac_f32 v37, v39, v39
    v_sub_f32 v38, v23, v32
    v_sub_f32 v39, v31, v33
    v_fmac_f32 v36, v38, v38
    v_fmac_f32 v37, v39, v39
    s_nop 1
    v_add_f32_dpp v36, v36, v36 row_ror:8 row_mask:0xf bank_mask:0xf
    v_add_f32_dpp v37, v37, v37 row_ror:8 row_mask:0xf bank_mask:0xf
    s_nop 1
    v_add_f32_dpp v36, v36, v36 row_ror:4 row_mask:0xf bank_mask:0xf
    v_add_f32_dpp v37, v37, v37 row_ror:4 row_mask:0xf bank_mask:0xf
    s_nop 1
    v_add_f32_dpp v36, v36, v36 row_ror:2 row_mask:0xf bank_mask:0xf
    v_add_f32_dpp v37, v37, v37 row_ror:2 row_mask:0xf bank_mask:0xf
    s_nop 1
    v_add_f32_dpp v36, v36, v36 row_ror:1 row_mask:0xf bank_mask:0xf
    v_add_f32_dpp v37, v37, v37 row_ror:1 row_mask:0xf bank_mask:0xf
    v_mov_b32 v34, v36
    v_mov_b32 v35, v37
    s_nop 1
    v_permlane16_swap_b32 v36, v34
    v_permlane16_swap_b32 v37, v35
    s_nop 0
    v_add_f32 v36, v36, v34
    v_add_f32 v37, v37, v35
    v_mov_b32 v34, v36
    v_mov_b32 v35, v37
    s_nop 1
    v_permlane32_swap_b32 v36, v34
    v_permlane32_swap_b32 v37, v35
    s_nop 0
    v_add_f32 v36, v36, v34
    v_add_f32 v37, v37, v35
    v_mul_f32 v36, 989855744, v36
    v_cvt_pk_bf16_f32 v32, v32, v32
    v_and_b32 v32, 0xffff0000, v32
    v_cvt_pk_bf16_f32 v36, v36, v36
    v_and_b32 v36, 0xffff0000, v36
    v_add_f32 v36, 925353388, v36
    v_cvt_pk_bf16_f32 v36, v36, v36
    v_and_b32 v36, 0xffff0000, v36
    v_sqrt_f32 v36, v36
    s_nop 0
    v_cvt_pk_bf16_f32 v36, v36, v36
    v_and_b32 v36, 0xffff0000, v36
    v_rcp_f32 v38, v36
    v_mul_f32 v37, 989855744, v37
    v_cvt_pk_bf16_f32 v33, v33, v33
    v_and_b32 v33, 0xffff0000, v33
    v_cvt_pk_bf16_f32 v37, v37, v37
    v_and_b32 v37, 0xffff0000, v37
    v_add_f32 v37, 925353388, v37
    v_cvt_pk_bf16_f32 v37, v37, v37
    v_and_b32 v37, 0xffff0000, v37
    v_sqrt_f32 v37, v37
    s_nop 0
    v_cvt_pk_bf16_f32 v37, v37, v37
    v_and_b32 v37, 0xffff0000, v37
    v_rcp_f32 v39, v37
    v_sub_f32 v16, v16, v32
    v_sub_f32 v17, v17, v32
    v_cvt_pk_bf16_f32 v40, v16, v17
    v_lshlrev_b32 v16, 16, v40
    v_and_b32 v17, 0xffff0000, v40
    v_mul_f32 v40, v16, v38
    v_mul_f32 v41, v17, v38
    v_fma_f32 v42, -v40, v36, v16
    v_fma_f32 v43, -v41, v36, v17
    v_fma_f32 v40, v42, v38, v40
    v_fma_f32 v41, v43, v38, v41
    v_cvt_pk_bf16_f32 v4, v40, v41
    v_sub_f32 v18, v18, v32
    v_sub_f32 v19, v19, v32
    v_cvt_pk_bf16_f32 v40, v18, v19
    v_lshlrev_b32 v18, 16, v40
    v_and_b32 v19, 0xffff0000, v40
    v_mul_f32 v40, v18, v38
    v_mul_f32 v41, v19, v38
    v_fma_f32 v42, -v40, v36, v18
    v_fma_f32 v43, -v41, v36, v19
    v_fma_f32 v40, v42, v38, v40
    v_fma_f32 v41, v43, v38, v41
    v_cvt_pk_bf16_f32 v5, v40, v41
    v_sub_f32 v20, v20, v32
    v_sub_f32 v21, v21, v32
    v_cvt_pk_bf16_f32 v40, v20, v21
    v_lshlrev_b32 v20, 16, v40
    v_and_b32 v21, 0xffff0000, v40
    v_mul_f32 v40, v20, v38
    v_mul_f32 v41, v21, v38
    v_fma_f32 v42, -v40, v36, v20
    v_fma_f32 v43, -v41, v36, v21
    v_fma_f32 v40, v42, v38, v40
    v_fma_f32 v41, v43, v38, v41
    v_cvt_pk_bf16_f32 v6, v40, v41
    v_sub_f32 v22, v22, v32
    v_sub_f32 v23, v23, v32
    v_cvt_pk_bf16_f32 v40, v22, v23
    v_lshlrev_b32 v22, 16, v40
    v_and_b32 v23, 0xffff0000, v40
    v_mul_f32 v40, v22, v38
    v_mul_f32 v41, v23, v38
    v_fma_f32 v42, -v40, v36, v22
    v_fma_f32 v43, -v41, v36, v23
    v_fma_f32 v40, v42, v38, v40
    v_fma_f32 v41, v43, v38, v41
    v_cvt_pk_bf16_f32 v7, v40, v41
    v_sub_f32 v24, v24, v33
    v_sub_f32 v25, v25, v33
    v_cvt_pk_bf16_f32 v40, v24, v25
    v_lshlrev_b32 v24, 16, v40
    v_and_b32 v25, 0xffff0000, v40
    v_mul_f32 v40, v24, v39
    v_mul_f32 v41, v25, v39
    v_fma_f32 v42, -v40, v37, v24
    v_fma_f32 v43, -v41, v37, v25
    v_fma_f32 v40, v42, v39, v40
    v_fma_f32 v41, v43, v39, v41
    v_cvt_pk_bf16_f32 v8, v40, v41
    v_sub_f32 v26, v26, v33
    v_sub_f32 v27, v27, v33
    v_cvt_pk_bf16_f32 v40, v26, v27
    v_lshlrev_b32 v26, 16, v40
    v_and_b32 v27, 0xffff0000, v40
    v_mul_f32 v40, v26, v39
    v_mul_f32 v41, v27, v39
    v_fma_f32 v42, -v40, v37, v26
    v_fma_f32 v43, -v41, v37, v27
    v_fma_f32 v40, v42, v39, v40
    v_fma_f32 v41, v43, v39, v41
    v_cvt_pk_bf16_f32 v9, v40, v41
    v_sub_f32 v28, v28, v33
    v_sub_f32 v29, v29, v33
    v_cvt_pk_bf16_f32 v40, v28, v29
    v_lshlrev_b32 v28, 16, v40
    v_and_b32 v29, 0xffff0000, v40
    v_mul_f32 v40, v28, v39
    v_mul_f32 v41, v29, v39
    v_fma_f32 v42, -v40, v37, v28
    v_fma_f32 v43, -v41, v37, v29
    v_fma_f32 v40, v42, v39, v40
    v_fma_f32 v41, v43, v39, v41
    v_cvt_pk_bf16_f32 v10, v40, v41
    v_sub_f32 v30, v30, v33
    v_sub_f32 v31, v31, v33
    v_cvt_pk_bf16_f32 v40, v30, v31
    v_lshlrev_b32 v30, 16, v40
    v_and_b32 v31, 0xffff0000, v40
    v_mul_f32 v40, v30, v39
    v_mul_f32 v41, v31, v39
    v_fma_f32 v42, -v40, v37, v30
    v_fma_f32 v43, -v41, v37, v31
    v_fma_f32 v40, v42, v39, v40
    v_fma_f32 v41, v43, v39, v41
    v_cvt_pk_bf16_f32 v11, v40, v41
    ds_write_b128 v1, v[4:7] offset:0
    ds_write_b128 v1, v[8:11] offset:1024
    v_lshlrev_b32 v54, 2, v50
    s_lshl_b32 s13, s11, 9
    v_add_u32 v53, s13, v54
    s_waitcnt lgkmcnt(0)
    s_cmp_eq_u32 s9, 2
    s_cbranch_scc1 L_notile
    v_mov_b32 v16, 0
    v_mov_b32 v17, 0
    v_mov_b32 v18, 0
    v_mov_b32 v19, 0
    v_mov_b32 v20, 0
    v_mov_b32 v21, 0
    v_mov_b32 v22, 0
    v_mov_b32 v23, 0
    v_mov_b32 v24, 0
    v_mov_b32 v25, 0
    v_mov_b32 v26, 0
    v_mov_b32 v27, 0
    v_mov_b32 v28, 0
    v_mov_b32 v29, 0
    v_mov_b32 v30, 0
    v_mov_b32 v31, 0
    ds_read_b32 v32, v53 offset:0
    ds_read_b32 v33, v53 offset:32
    ds_read_b32 v34, v53 offset:64
    ds_read_b32 v35, v53 offset:96
    ds_read_b32 v36, v53 offset:128
    ds_read_b32 v37, v53 offset:160
    ds_read_b32 v38, v53 offset:192
    ds_read_b32 v39, v53 offset:224
    ds_read_b32 v40, v53 offset:1024
    ds_read_b32 v41, v53 offset:1056
    ds_read_b32 v42, v53 offset:1088
    ds_read_b32 v43, v53 offset:1120
    ds_read_b32 v44, v53 offset:1152
    ds_read_b32 v45, v53 offset:1184
    ds_read_b32 v46, v53 offset:1216
    ds_read_b32 v47, v53 offset:1248
    s_waitcnt vmcnt(16) lgkmcnt(0)
    v_perm_b32 v12, v68, v64, s80
    v_perm_b32 v13, v68, v64, s81
    v_dot2c_f32_bf16 v16, v12, v32
    v_dot2c_f32_bf16 v17, v13, v32
    v_dot2c_f32_bf16 v24, v12, v40
    v_dot2c_f32_bf16 v25, v13, v40
    v_perm_b32 v12, v69, v65, s80
    v_perm_b32 v13, v69, v65, s81
    v_dot2c_f32_bf16 v18, v12, v32
    v_dot2c_f32_bf16 v19, v13, v32
    v_dot2c_f32_bf16 v26, v12, v40
    v_dot2c_f32_bf16 v27, v13, v40
    v_perm_b32 v12, v70, v66, s80
    v_perm_b32 v13, v70, v66, s81
    v_dot2c_f32_bf16 v20, v12, v32
    v_dot2c_f32_bf16 v21, v13, v32
    v_dot2c_f32_bf16 v28, v12, v40
    v_dot2c_f32_bf16 v29, v13, v40
    v_perm_b32 v12, v71, v67, s80
    v_perm_b32 v13, v71, v67, s81
    v_dot2c_f32_bf16 v22, v12, v32
    v_dot2c_f32_bf16 v23, v13, v32
    v_dot2c_f32_bf16 v30, v12, v40
    v_dot2c_f32_bf16 v31, v13, v40
    v_perm_b32 v12, v76, v72, s80
    v_perm_b32 v13, v76, v72, s81
    v_dot2c_f32_bf16 v16, v12, v33
    v_dot2c_f32_bf16 v17, v13, v33
    v_dot2c_f32_bf16 v24, v12, v41
    v_dot2c_f32_bf16 v25, v13, v41
    v_perm_b32 v12, v77, v73, s80
    v_perm_b32 v13, v77, v73, s81
    v_dot2c_f32_bf16 v18, v12, v33
    v_dot2c_f32_bf16 v19, v13, v33
    v_dot2c_f32_bf16 v26, v12, v41
    v_dot2c_f32_bf16 v27, v13, v41
    v_perm_b32 v12, v78, v74, s80
    v_perm_b32 v13, v78, v74, s81
    v_dot2c_f32_bf16 v20, v12, v33
    v_dot2c_f32_bf16 v21, v13, v33
    v_dot2c_f32_bf16 v28, v12, v41
    v_dot2c_f32_bf16 v29, v13, v41
    v_perm_b32 v12, v79, v75, s80
    v_perm_b32 v13, v79, v75, s81
    v_dot2c_f32_bf16 v22, v12, v33
    v_dot2c_f32_bf16 v23, v13, v33
    v_dot2c_f32_bf16 v30, v12, v41
    v_dot2c_f32_bf16 v31, v13, v41
    v_perm_b32 v12, v84, v80, s80
    v_perm_b32 v13, v84, v80, s81
    v_dot2c_f32_bf16 v16, v12, v34
    v_dot2c_f32_bf16 v17, v13, v34
    v_dot2c_f32_bf16 v24, v12, v42
    v_dot2c_f32_bf16 v25, v13, v42
    v_perm_b32 v12, v85, v81, s80
    v_perm_b32 v13, v85, v81, s81
    v_dot2c_f32_bf16 v18, v12, v34
    v_dot2c_f32_bf16 v19, v13, v34
    v_dot2c_f32_bf16 v26, v12, v42
    v_dot2c_f32_bf16 v27, v13, v42
    v_perm_b32 v12, v86, v82, s80
    v_perm_b32 v13, v86, v82, s81
    v_dot2c_f32_bf16 v20, v12, v34
    v_dot2c_f32_bf16 v21, v13, v34
    v_dot2c_f32_bf16 v28, v12, v42
    v_dot2c_f32_bf16 v29, v13, v42
    v_perm_b32 v12, v87, v83, s80
    v_perm_b32 v13, v87, v83, s81
    v_dot2c_f32_bf16 v22, v12, v34
    v_dot2c_f32_bf16 v23, v13, v34
    v_dot2c_f32_bf16 v30, v12, v42
    v_dot2c_f32_bf16 v31, v13, v42
    v_perm_b32 v12, v92, v88, s80
    v_perm_b32 v13, v92, v88, s81
    v_dot2c_f32_bf16 v16, v12, v35
    v_dot2c_f32_bf16 v17, v13, v35
    v_dot2c_f32_bf16 v24, v12, v43
    v_dot2c_f32_bf16 v25, v13, v43
    v_perm_b32 v12, v93, v89, s80
    v_perm_b32 v13, v93, v89, s81
    v_dot2c_f32_bf16 v18, v12, v35
    v_dot2c_f32_bf16 v19, v13, v35
    v_dot2c_f32_bf16 v26, v12, v43
    v_dot2c_f32_bf16 v27, v13, v43
    v_perm_b32 v12, v94, v90, s80
    v_perm_b32 v13, v94, v90, s81
    v_dot2c_f32_bf16 v20, v12, v35
    v_dot2c_f32_bf16 v21, v13, v35
    v_dot2c_f32_bf16 v28, v12, v43
    v_dot2c_f32_bf16 v29, v13, v43
    v_perm_b32 v12, v95, v91, s80
    v_perm_b32 v13, v95, v91, s81
    v_dot2c_f32_bf16 v22, v12, v35
    v_dot2c_f32_bf16 v23, v13, v35
    v_dot2c_f32_bf16 v30, v12, v43
    v_dot2c_f32_bf16 v31, v13, v43
    v_perm_b32 v12, v100, v96, s80
    v_perm_b32 v13, v100, v96, s81
    v_dot2c_f32_bf16 v16, v12, v36
    v_dot2c_f32_bf16 v17, v13, v36
    v_dot2c_f32_bf16 v24, v12, v44
    v_dot2c_f32_bf16 v25, v13, v44
    v_perm_b32 v12, v101, v97, s80
    v_perm_b32 v13, v101, v97, s81
    v_dot2c_f32_bf16 v18, v12, v36
    v_dot2c_f32_bf16 v19, v13, v36
    v_dot2c_f32_bf16 v26, v12, v44
    v_dot2c_f32_bf16 v27, v13, v44
    v_perm_b32 v12, v102, v98, s80
    v_perm_b32 v13, v102, v98, s81
    v_dot2c_f32_bf16 v20, v12, v36
    v_dot2c_f32_bf16 v21, v13, v36
    v_dot2c_f32_bf16 v28, v12, v44
    v_dot2c_f32_bf16 v29, v13, v44
    v_perm_b32 v12, v103, v99, s80
    v_perm_b32 v13, v103, v99, s81
    v_dot2c_f32_bf16 v22, v12, v36
    v_dot2c_f32_bf16 v23, v13, v36
    v_dot2c_f32_bf16 v30, v12, v44
    v_dot2c_f32_bf16 v31, v13, v44
    v_perm_b32 v12, v108, v104, s80
    v_perm_b32 v13, v108, v104, s81
    v_dot2c_f32_bf16 v16, v12, v37
    v_dot2c_f32_bf16 v17, v13, v37
    v_dot2c_f32_bf16 v24, v12, v45
    v_dot2c_f32_bf16 v25, v13, v45
    v_perm_b32 v12, v109, v105, s80
    v_perm_b32 v13, v109, v105, s81
    v_dot2c_f32_bf16 v18, v12, v37
    v_dot2c_f32_bf16 v19, v13, v37
    v_dot2c_f32_bf16 v26, v12, v45
    v_dot2c_f32_bf16 v27, v13, v45
    v_perm_b32 v12, v110, v106, s80
    v_perm_b32 v13, v110, v106, s81
    v_dot2c_f32_bf16 v20, v12, v37
    v_dot2c_f32_bf16 v21, v13, v37
    v_dot2c_f32_bf16 v28, v12, v45
    v_dot2c_f32_bf16 v29, v13, v45
    v_perm_b32 v12, v111, v107, s80
    v_perm_b32 v13, v111, v107, s81
    v_dot2c_f32_bf16 v22, v12, v37
    v_dot2c_f32_bf16 v23, v13, v37
    v_dot2c_f32_bf16 v30, v12, v45
    v_dot2c_f32_bf16 v31, v13, v45
    v_perm_b32 v12, v116, v112, s80
    v_perm_b32 v13, v116, v112, s81
    v_dot2c_f32_bf16 v16, v12, v38
    v_dot2c_f32_bf16 v17, v13, v38
    v_dot2c_f32_bf16 v24, v12, v46
    v_dot2c_f32_bf16 v25, v13, v46
    v_perm_b32 v12, v117, v113, s80
    v_perm_b32 v13, v117, v113, s81
    v_dot2c_f32_bf16 v18, v12, v38
    v_dot2c_f32_bf16 v19, v13, v38
    v_dot2c_f32_bf16 v26, v12, v46
    v_dot2c_f32_bf16 v27, v13, v46
    v_perm_b32 v12, v118, v114, s80
    v_perm_b32 v13, v118, v114, s81
    v_dot2c_f32_bf16 v20, v12, v38
    v_dot2c_f32_bf16 v21, v13, v38
    v_dot2c_f32_bf16 v28, v12, v46
    v_dot2c_f32_bf16 v29, v13, v46
    v_perm_b32 v12, v119, v115, s80
    v_perm_b32 v13, v119, v115, s81
    v_dot2c_f32_bf16 v22, v12, v38
    v_dot2c_f32_bf16 v23, v13, v38
    v_dot2c_f32_bf16 v30, v12, v46
    v_dot2c_f32_bf16 v31, v13, v46
    v_perm_b32 v12, v124, v120, s80
    v_perm_b32 v13, v124, v120, s81
    v_dot2c_f32_bf16 v16, v12, v39
    v_dot2c_f32_bf16 v17, v13, v39
    v_dot2c_f32_bf16 v24, v12, v47
    v_dot2c_f32_bf16 v25, v13, v47
    v_perm_b32 v12, v125, v121, s80
    v_perm_b32 v13, v125, v121, s81
    v_dot2c_f32_bf16 v18, v12, v39
    v_dot2c_f32_bf16 v19, v13, v39
    v_dot2c_f32_bf16 v26, v12, v47
    v_dot2c_f32_bf16 v27, v13, v47
    v_perm_b32 v12, v126, v122, s80
    v_perm_b32 v13, v126, v122, s81
    v_dot2c_f32_bf16 v20, v12, v39
    v_dot2c_f32_bf16 v21, v13, v39
    v_dot2c_f32_bf16 v28, v12, v47
    v_dot2c_f32_bf16 v29, v13, v47
    v_perm_b32 v12, v127, v123, s80
    v_perm_b32 v13, v127, v123, s81
    v_dot2c_f32_bf16 v22, v12, v39
    v_dot2c_f32_bf16 v23, v13, v39
    v_dot2c_f32_bf16 v30, v12, v47
    v_dot2c_f32_bf16 v31, v13, v47
    ds_read_b32 v32, v53 offset:256
    ds_read_b32 v33, v53 offset:288
    ds_read_b32 v34, v53 offset:320
    ds_read_b32 v35, v53 offset:352
    ds_read_b32 v36, v53 offset:384
    ds_read_b32 v37, v53 offset:416
    ds_read_b32 v38, v53 offset:448
    ds_read_b32 v39, v53 offset:480
    ds_read_b32 v40, v53 offset:1280
    ds_read_b32 v41, v53 offset:1312
    ds_read_b32 v42, v53 offset:1344
    ds_read_b32 v43, v53 offset:1376
    ds_read_b32 v44, v53 offset:1408
    ds_read_b32 v45, v53 offset:1440
    ds_read_b32 v46, v53 offset:1472
    ds_read_b32 v47, v53 offset:1504
    s_waitcnt vmcnt(0) lgkmcnt(0)
    buffer_load_dwordx2 v[48:49], v15, s[52:55], 0 offen
    v_perm_b32 v12, v132, v128, s80
    v_perm_b32 v13, v132, v128, s81
    v_dot2c_f32_bf16 v16, v12, v32
    v_dot2c_f32_bf16 v17, v13, v32
    v_dot2c_f32_bf16 v24, v12, v40
    v_dot2c_f32_bf16 v25, v13, v40
    v_perm_b32 v12, v133, v129, s80
    v_perm_b32 v13, v133, v129, s81
    v_dot2c_f32_bf16 v18, v12, v32
    v_dot2c_f32_bf16 v19, v13, v32
    v_dot2c_f32_bf16 v26, v12, v40
    v_dot2c_f32_bf16 v27, v13, v40
    v_perm_b32 v12, v134, v130, s80
    v_perm_b32 v13, v134, v130, s81
    v_dot2c_f32_bf16 v20, v12, v32
    v_dot2c_f32_bf16 v21, v13, v32
    v_dot2c_f32_bf16 v28, v12, v40
    v_dot2c_f32_bf16 v29, v13, v40
    v_perm_b32 v12, v135, v131, s80
    v_perm_b32 v13, v135, v131, s81
    v_dot2c_f32_bf16 v22, v12, v32
    v_dot2c_f32_bf16 v23, v13, v32
    v_dot2c_f32_bf16 v30, v12, v40
    v_dot2c_f32_bf16 v31, v13, v40
    v_perm_b32 v12, v140, v136, s80
    v_perm_b32 v13, v140, v136, s81
    v_dot2c_f32_bf16 v16, v12, v33
    v_dot2c_f32_bf16 v17, v13, v33
    v_dot2c_f32_bf16 v24, v12, v41
    v_dot2c_f32_bf16 v25, v13, v41
    v_perm_b32 v12, v141, v137, s80
    v_perm_b32 v13, v141, v137, s81
    v_dot2c_f32_bf16 v18, v12, v33
    v_dot2c_f32_bf16 v19, v13, v33
    v_dot2c_f32_bf16 v26, v12, v41
    v_dot2c_f32_bf16 v27, v13, v41
    v_perm_b32 v12, v142, v138, s80
    v_perm_b32 v13, v142, v138, s81
    v_dot2c_f32_bf16 v20, v12, v33
    v_dot2c_f32_bf16 v21, v13, v33
    v_dot2c_f32_bf16 v28, v12, v41
    v_dot2c_f32_bf16 v29, v13, v41
    v_perm_b32 v12, v143, v139, s80
    v_perm_b32 v13, v143, v139, s81
    v_dot2c_f32_bf16 v22, v12, v33
    v_dot2c_f32_bf16 v23, v13, v33
    v_dot2c_f32_bf16 v30, v12, v41
    v_dot2c_f32_bf16 v31, v13, v41
    v_perm_b32 v12, v148, v144, s80
    v_perm_b32 v13, v148, v144, s81
    v_dot2c_f32_bf16 v16, v12, v34
    v_dot2c_f32_bf16 v17, v13, v34
    v_dot2c_f32_bf16 v24, v12, v42
    v_dot2c_f32_bf16 v25, v13, v42
    v_perm_b32 v12, v149, v145, s80
    v_perm_b32 v13, v149, v145, s81
    v_dot2c_f32_bf16 v18, v12, v34
    v_dot2c_f32_bf16 v19, v13, v34
    v_dot2c_f32_bf16 v26, v12, v42
    v_dot2c_f32_bf16 v27, v13, v42
    v_perm_b32 v12, v150, v146, s80
    v_perm_b32 v13, v150, v146, s81
    v_dot2c_f32_bf16 v20, v12, v34
    v_dot2c_f32_bf16 v21, v13, v34
    v_dot2c_f32_bf16 v28, v12, v42
    v_dot2c_f32_bf16 v29, v13, v42
    v_perm_b32 v12, v151, v147, s80
    v_perm_b32 v13, v151, v147, s81
    v_dot2c_f32_bf16 v22, v12, v34
    v_dot2c_f32_bf16 v23, v13, v34
    v_dot2c_f32_bf16 v30, v12, v42
    v_dot2c_f32_bf16 v31, v13, v42
    v_perm_b32 v12, v156, v152, s80
    v_perm_b32 v13, v156, v152, s81
    v_dot2c_f32_bf16 v16, v12, v35
    v_dot2c_f32_bf16 v17, v13, v35
    v_dot2c_f32_bf16 v24, v12, v43
    v_dot2c_f32_bf16 v25, v13, v43
    v_perm_b32 v12, v157, v153, s80
    v_perm_b32 v13, v157, v153, s81
    v_dot2c_f32_bf16 v18, v12, v35
    v_dot2c_f32_bf16 v19, v13, v35
    v_dot2c_f32_bf16 v26, v12, v43
    v_dot2c_f32_bf16 v27, v13, v43
    v_perm_b32 v12, v158, v154, s80
    v_perm_b32 v13, v158, v154, s81
    v_dot2c_f32_bf16 v20, v12, v35
    v_dot2c_f32_bf16 v21, v13, v35
    v_dot2c_f32_bf16 v28, v12, v43
    v_dot2c_f32_bf16 v29, v13, v43
    v_perm_b32 v12, v159, v155, s80
    v_perm_b32 v13, v159, v155, s81
    v_dot2c_f32_bf16 v22, v12, v35
    v_dot2c_f32_bf16 v23, v13, v35
    v_dot2c_f32_bf16 v30, v12, v43
    v_dot2c_f32_bf16 v31, v13, v43
    v_perm_b32 v12, v164, v160, s80
    v_perm_b32 v13, v164, v160, s81
    v_dot2c_f32_bf16 v16, v12, v36
    v_dot2c_f32_bf16 v17, v13, v36
    v_dot2c_f32_bf16 v24, v12, v44
    v_dot2c_f32_bf16 v25, v13, v44
    v_perm_b32 v12, v165, v161, s80
    v_perm_b32 v13, v165, v161, s81
    v_dot2c_f32_bf16 v18, v12, v36
    v_dot2c_f32_bf16 v19, v13, v36
    v_dot2c_f32_bf16 v26, v12, v44
    v_dot2c_f32_bf16 v27, v13, v44
    v_perm_b32 v12, v166, v162, s80
    v_perm_b32 v13, v166, v162, s81
    v_dot2c_f32_bf16 v20, v12, v36
    v_dot2c_f32_bf16 v21, v13, v36
    v_dot2c_f32_bf16 v28, v12, v44
    v_dot2c_f32_bf16 v29, v13, v44
    v_perm_b32 v12, v167, v163, s80
    v_perm_b32 v13, v167, v163, s81
    v_dot2c_f32_bf16 v22, v12, v36
    v_dot2c_f32_bf16 v23, v13, v36
    v_dot2c_f32_bf16 v30, v12, v44
    v_dot2c_f32_bf16 v31, v13, v44
    v_perm_b32 v12, v172, v168, s80
    v_perm_b32 v13, v172, v168, s81
    v_dot2c_f32_bf16 v16, v12, v37
    v_dot2c_f32_bf16 v17, v13, v37
    v_dot2c_f32_bf16 v24, v12, v45
    v_dot2c_f32_bf16 v25, v13, v45
    v_perm_b32 v12, v173, v169, s80
    v_perm_b32 v13, v173, v169, s81
    v_dot2c_f32_bf16 v18, v12, v37
    v_dot2c_f32_bf16 v19, v13, v37
    v_dot2c_f32_bf16 v26, v12, v45
    v_dot2c_f32_bf16 v27, v13, v45
    v_perm_b32 v12, v174, v170, s80
    v_perm_b32 v13, v174, v170, s81
    v_dot2c_f32_bf16 v20, v12, v37
    v_dot2c_f32_bf16 v21, v13, v37
    v_dot2c_f32_bf16 v28, v12, v45
    v_dot2c_f32_bf16 v29, v13, v45
    v_perm_b32 v12, v175, v171, s80
    v_perm_b32 v13, v175, v171, s81
    v_dot2c_f32_bf16 v22, v12, v37
    v_dot2c_f32_bf16 v23, v13, v37
    v_dot2c_f32_bf16 v30, v12, v45
    v_dot2c_f32_bf16 v31, v13, v45
    v_perm_b32 v12, v180, v176, s80
    v_perm_b32 v13, v180, v176, s81
    v_dot2c_f32_bf16 v16, v12, v38
    v_dot2c_f32_bf16 v17, v13, v38
    v_dot2c_f32_bf16 v24, v12, v46
    v_dot2c_f32_bf16 v25, v13, v46
    v_perm_b32 v12, v181, v177, s80
    v_perm_b32 v13, v181, v177, s81
    v_dot2c_f32_bf16 v18, v12, v38
    v_dot2c_f32_bf16 v19, v13, v38
    v_dot2c_f32_bf16 v26, v12, v46
    v_dot2c_f32_bf16 v27, v13, v46
    v_perm_b32 v12, v182, v178, s80
    v_perm_b32 v13, v182, v178, s81
    v_dot2c_f32_bf16 v20, v12, v38
    v_dot2c_f32_bf16 v21, v13, v38
    v_dot2c_f32_bf16 v28, v12, v46
    v_dot2c_f32_bf16 v29, v13, v46
    v_perm_b32 v12, v183, v179, s80
    v_perm_b32 v13, v183, v179, s81
    v_dot2c_f32_bf16 v22, v12, v38
    v_dot2c_f32_bf16 v23, v13, v38
    v_dot2c_f32_bf16 v30, v12, v46
    v_dot2c_f32_bf16 v31, v13, v46
    v_perm_b32 v12, v188, v184, s80
    v_perm_b32 v13, v188, v184, s81
    v_dot2c_f32_bf16 v16, v12, v39
    v_dot2c_f32_bf16 v17, v13, v39
    v_dot2c_f32_bf16 v24, v12, v47
    v_dot2c_f32_bf16 v25, v13, v47
    v_perm_b32 v12, v189, v185, s80
    v_perm_b32 v13, v189, v185, s81
    v_dot2c_f32_bf16 v18, v12, v39
    v_dot2c_f32_bf16 v19, v13, v39
    v_dot2c_f32_bf16 v26, v12, v47
    v_dot2c_f32_bf16 v27, v13, v47
    v_perm_b32 v12, v190, v186, s80
    v_perm_b32 v13, v190, v186, s81
    v_dot2c_f32_bf16 v20, v12, v39
    v_dot2c_f32_bf16 v21, v13, v39
    v_dot2c_f32_bf16 v28, v12, v47
    v_dot2c_f32_bf16 v29, v13, v47
    v_perm_b32 v12, v191, v187, s80
    v_perm_b32 v13, v191, v187, s81
    v_dot2c_f32_bf16 v22, v12, v39
    v_dot2c_f32_bf16 v23, v13, v39
    v_dot2c_f32_bf16 v30, v12, v47
    v_dot2c_f32_bf16 v31, v13, v47
    s_nop 2
    v_permlane32_swap_b32 v16, v24
    v_permlane32_swap_b32 v17, v25
    v_permlane32_swap_b32 v18, v26
    v_permlane32_swap_b32 v19, v27
    v_permlane32_swap_b32 v20, v28
    v_permlane32_swap_b32 v21, v29
    v_permlane32_swap_b32 v22, v30
    v_permlane32_swap_b32 v23, v31
    s_nop 0
    v_add_f32 v16, v16, v24
    v_add_f32 v17, v17, v25
    v_add_f32 v18, v18, v26
    v_add_f32 v19, v19, v27
    v_add_f32 v20, v20, v28
    v_add_f32 v21, v21, v29
    v_add_f32 v22, v22, v30
    v_add_f32 v23, v23, v31
    s_nop 1
    v_permlane16_swap_b32 v16, v20
    v_permlane16_swap_b32 v17, v21
    v_permlane16_swap_b32 v18, v22
    v_permlane16_swap_b32 v19, v23
    s_nop 0
    v_add_f32 v16, v16, v20
    v_add_f32 v17, v17, v21
    v_add_f32 v18, v18, v22
    v_add_f32 v19, v19, v23
    s_nop 1
    v_add_f32_dpp v16, v16, v16 row_ror:8 row_mask:0xf bank_mask:0xf
    v_add_f32_dpp v17, v17, v17 row_ror:8 row_mask:0xf bank_mask:0xf
    v_add_f32_dpp v18, v18, v18 row_ror:8 row_mask:0xf bank_mask:0xf
    v_add_f32_dpp v19, v19, v19 row_ror:8 row_mask:0xf bank_mask:0xf
    s_branch L_tiled
L_notile:
    s_sleep 48
    buffer_load_dwordx2 v[48:49], v15, s[52:55], 0 offen
L_tiled:
    s_cmp_eq_u32 s2, 0
    s_cbranch_scc1 L_havenonce
    s_waitcnt vmcnt(0)
    v_cmp_eq_u32 vcc, 0, v48
    s_cbranch_vccz L_gotnonce
    s_mov_b32 s90, 65536
L_poll_3:
    buffer_load_dwordx2 v[48:49], v15, s[52:55], 0 offen sc1
    s_waitcnt vmcnt(0)
    v_cmp_eq_u32 vcc, 0, v48
    s_cbranch_vccz L_pdone_4
    s_sleep 8
    s_sub_u32 s90, s90, 1
    s_cmp_lg_u32 s90, 0
    s_cbranch_scc1 L_poll_3
L_pdone_4:
L_gotnonce:
    v_readfirstlane_b32 s88, v48
    v_readfirstlane_b32 s89, v49
    s_nop 1
L_havenonce:
    v_mov_b32 v6, s88
    v_mov_b32 v7, s89
    v_mov_b32 v10, s88
    v_mov_b32 v11, s89
    v_lshl_add_u32 v52, v14, 7, v62
    s_cmp_eq_u32 s9, 2
    s_cbranch_scc1 L_nost
    s_cmp_eq_u32 s9, 1
    s_cbranch_scc1 L_st1
    v_lshl_add_u32 v13, v3, 16, v52
    s_lshl_b32 s12, s4, 13
    s_lshl_b32 s13, s11, 12
    s_add_u32 s12, s12, s13
    s_lshl_b32 s13, s10, 9
    s_add_u32 s12, s12, s13
    s_branch L_st2
L_st1:
    v_lshl_add_u32 v13, v3, 9, v52
    s_lshl_b32 s12, s10, 12
    s_lshl_b32 s13, s85, 1
    s_add_u32 s13, s13, s11
    s_lshl_b32 s13, s13, 10
    s_add_u32 s12, s12, s13
    s_add_u32 s12, s12, 163840
L_st2:
    v_mov_b32 v4, v16
    v_mov_b32 v5, v17
    v_mov_b32 v8, v18
    v_mov_b32 v9, v19
    s_mov_b64 exec, s[76:77]
    buffer_store_dwordx4 v[4:7], v13, s[48:51], s12 offen sc1
    buffer_store_dwordx4 v[8:11], v13, s[48:51], s12 offen offset:256 sc1
    s_mov_b64 exec, -1
L_nost:
    s_sleep 64
    s_lshl_b32 s12, s8, 13
    s_add_u32 s13, s12, 4096
    s_mov_b64 s[72:73], -1
    s_mov_b64 s[74:75], -1
    s_mov_b64 s[96:97], -1
    s_mov_b64 s[98:99], -1
    s_mov_b32 s90, 65536
L_poll_5:
    s_mov_b64 exec, s[72:73]
    s_cbranch_execz L_sk_6
    buffer_load_dwordx4 v[64:67], v1, s[48:51], s12 offen offset:0 sc1
    buffer_load_dwordx4 v[68:71], v1, s[48:51], s12 offen offset:1024 sc1
L_sk_6:
    s_mov_b64 exec, s[74:75]
    s_cbranch_execz L_sk_7
    buffer_load_dwordx4 v[72:75], v1, s[48:51], s12 offen offset:2048 sc1
    buffer_load_dwordx4 v[76:79], v1, s[48:51], s12 offen offset:3072 sc1
L_sk_7:
    s_mov_b64 exec, s[96:97]
    s_cbranch_execz L_sk_8
    buffer_load_dwordx4 v[80:83], v1, s[48:51], s13 offen offset:0 sc1
    buffer_load_dwordx4 v[84:87], v1, s[48:51], s13 offen offset:1024 sc1
L_sk_8:
    s_mov_b64 exec, s[98:99]
    s_cbranch_execz L_sk_9
    buffer_load_dwordx4 v[88:91], v1, s[48:51], s13 offen offset:2048 sc1
    buffer_load_dwordx4 v[92:95], v1, s[48:51], s13 offen offset:3072 sc1
L_sk_9:
    s_waitcnt vmcnt(0)
    s_mov_b64 exec, s[72:73]
    v_cmp_ne_u64 vcc, s[88:89], v[66:67]
    v_cmp_ne_u64 s[94:95], s[88:89], v[70:71]
    s_or_b64 vcc, vcc, s[94:95]
    s_mov_b64 s[72:73], vcc
    s_mov_b64 exec, s[74:75]
    v_cmp_ne_u64 vcc, s[88:89], v[74:75]
    v_cmp_ne_u64 s[94:95], s[88:89], v[78:79]
    s_or_b64 vcc, vcc, s[94:95]
    s_mov_b64 s[74:75], vcc
    s_mov_b64 exec, s[96:97]
    v_cmp_ne_u64 vcc, s[88:89], v[82:83]
    v_cmp_ne_u64 s[94:95], s[88:89], v[86:87]
    s_or_b64 vcc, vcc, s[94:95]
    s_mov_b64 s[96:97], vcc
    s_mov_b64 exec, s[98:99]
    v_cmp_ne_u64 vcc, s[88:89], v[90:91]
    v_cmp_ne_u64 s[94:95], s[88:89], v[94:95]
    s_or_b64 vcc, vcc, s[94:95]
    s_mov_b64 s[98:99], vcc
    s_mov_b64 exec, -1
    s_mov_b64 vcc, s[72:73]
    s_or_b64 vcc, vcc, s[74:75]
    s_or_b64 vcc, vcc, s[96:97]
    s_or_b64 vcc, vcc, s[98:99]
    s_cbranch_vccz L_pdone_10
    s_sleep 8
    s_sub_u32 s90, s90, 1
    s_cmp_lg_u32 s90, 0
    s_cbranch_scc1 L_poll_5
L_pdone_10:
L_noga:
    v_lshrrev_b32 v13, 5, v0
    v_lshlrev_b32 v13, 7, v13
    v_lshl_add_u32 v13, v51, 4, v13
    v_bfe_u32 v12, v0, 3, 1
    v_lshl_add_u32 v13, v12, 3, v13
    v_bfe_u32 v12, v0, 4, 1
    v_lshl_add_u32 v13, v12, 2, v13
    v_add_f32 v64, v64, v80
    v_add_f32 v65, v65, v81
    v_add_f32 v68, v68, v84
    v_add_f32 v69, v69, v85
    v_add_f32 v72, v72, v88
    v_add_f32 v73, v73, v89
    v_add_f32 v76, v76, v92
    v_add_f32 v77, v77, v93
    v_cvt_pk_bf16_f32 v16, v64, v65
    v_cvt_pk_bf16_f32 v17, v68, v69
    v_cvt_pk_bf16_f32 v18, v72, v73
    v_cvt_pk_bf16_f32 v19, v76, v77
    ds_write_b32 v13, v16 offset:2048
    ds_write_b32 v13, v17 offset:2304
    ds_write_b32 v13, v18 offset:2560
    ds_write_b32 v13, v19 offset:2816
    v_mov_b32 v12, 12416
    v_mov_b32 v13, 1
    s_waitcnt lgkmcnt(0)
    ds_write_b32 v12, v13 offset:4
    s_setprio 0
    s_cmp_lg_u32 s9, 1
    s_cbranch_scc1 L_nof1
    s_add_u32 s12, s85, s11
    s_cmp_lg_u32 s12, 0
    s_cbranch_scc1 L_nohc
    s_lshl_b32 s12, s10, 12
    s_add_u32 s12, s12, 163840
    s_mov_b32 s90, 65536
L_poll_11:
    buffer_load_dwordx4 v[64:67], v1, s[48:51], s12 offen offset:0 sc1
    buffer_load_dwordx4 v[68:71], v1, s[48:51], s12 offen offset:1024 sc1
    buffer_load_dwordx4 v[72:75], v1, s[48:51], s12 offen offset:2048 sc1
    buffer_load_dwordx4 v[76:79], v1, s[48:51], s12 offen offset:3072 sc1
    s_waitcnt vmcnt(0)
    v_cmp_ne_u64 vcc, s[88:89], v[66:67]
    v_cmp_ne_u64 s[94:95], s[88:89], v[70:71]
    s_or_b64 vcc, vcc, s[94:95]
    v_cmp_ne_u64 s[94:95], s[88:89], v[74:75]
    s_or_b64 vcc, vcc, s[94:95]
    v_cmp_ne_u64 s[94:95], s[88:89], v[78:79]
    s_or_b64 vcc, vcc, s[94:95]
    s_cbranch_vccz L_pdone_12
    s_sleep 8
    s_sub_u32 s90, s90, 1
    s_cmp_lg_u32 s90, 0
    s_cbranch_scc1 L_poll_11
L_pdone_12:
    v_add_f32 v64, v64, v68
    v_add_f32 v72, v72, v76
    v_add_f32 v65, v65, v69
    v_add_f32 v73, v73, v77
    v_cvt_pk_bf16_f32 v64, v64, v64
    v_and_b32 v64, 0xffff0000, v64
    v_cvt_pk_bf16_f32 v72, v72, v72
    v_and_b32 v72, 0xffff0000, v72
    v_mul_f32 v12, s83, v64
    v_exp_f32 v12, v12
    s_nop 0
    v_add_f32 v12, 1.0, v12
    v_rcp_f32 v12, v12
    s_nop 0
    v_mul_f32 v64, v64, v12
    v_cvt_pk_bf16_f32 v64, v64, v64
    v_and_b32 v64, 0xffff0000, v64
    v_mul_f32 v64, v64, v72
    v_cvt_pk_bf16_f32 v65, v65, v65
    v_and_b32 v65, 0xffff0000, v65
    v_cvt_pk_bf16_f32 v73, v73, v73
    v_and_b32 v73, 0xffff0000, v73
    v_mul_f32 v12, s83, v65
    v_exp_f32 v12, v12
    s_nop 0
    v_add_f32 v12, 1.0, v12
    v_rcp_f32 v12, v12
    s_nop 0
    v_mul_f32 v65, v65, v12
    v_cvt_pk_bf16_f32 v65, v65, v65
    v_and_b32 v65, 0xffff0000, v65
    v_mul_f32 v65, v65, v73
    v_cvt_pk_bf16_f32 v4, v64, v65
    v_cvt_pk_bf16_f32 v5, v64, v65
    s_nop 1
    v_permlane16_swap_b32 v4, v5
    v_lshrrev_b32 v12, 5, v0
    v_lshlrev_b32 v12, 13, v12
    v_lshl_add_u32 v12, v51, 5, v12
    v_bfe_u32 v13, v0, 3, 1
    v_lshl_add_u32 v12, v13, 4, v12
    s_lshl_b32 s12, s10, 8
    s_add_u32 s12, s12, 131072
    s_mov_b32 s78, 0x0000ffff
    s_mov_b32 s79, 0x0000ffff
    s_mov_b64 exec, s[78:79]
    buffer_store_dwordx4 v[4:7], v12, s[48:51], s12 offen sc1
    s_mov_b64 exec, -1
    s_branch L_nohc
L_nof1:
    s_cmp_ge_u32 s6, 4
    s_cbranch_scc1 L_nohc
    s_lshl_b32 s10, s8, 2
    s_add_u32 s10, s10, s6
    s_and_b32 s11, s10, 7
    s_lshr_b32 s10, s10, 3
    s_mul_i32 s12, s10, 229376
    s_lshl_b32 s13, s11, 7
    s_add_u32 s12, s12, s13
    v_lshl_add_u32 v12, v50, 11, v62
    v_add_u32 v12, s12, v12
    s_mov_b32 s14, 0
    buffer_load_dwordx4 v[64:67], v12, s[56:59], s14 offen offset:0 nt
    buffer_load_dwordx4 v[68:71], v12, s[56:59], s14 offen offset:1024 nt
    s_add_u32 s14, s14, 16384
    buffer_load_dwordx4 v[72:75], v12, s[56:59], s14 offen offset:0 nt
    buffer_load_dwordx4 v[76:79], v12, s[56:59], s14 offen offset:1024 nt
    s_add_u32 s14, s14, 16384
    buffer_load_dwordx4 v[80:83], v12, s[56:59], s14 offen offset:0 nt
    buffer_load_dwordx4 v[84:87], v12, s[56:59], s14 offen offset:1024 nt
    s_add_u32 s14, s14, 16384
    buffer_load_dwordx4 v[88:91], v12, s[56:59], s14 offen offset:0 nt
    buffer_load_dwordx4 v[92:95], v12, s[56:59], s14 offen offset:1024 nt
    s_add_u32 s14, s14, 16384
    buffer_load_dwordx4 v[96:99], v12, s[56:59], s14 offen offset:0 nt
    buffer_load_dwordx4 v[100:103], v12, s[56:59], s14 offen offset:1024 nt
    s_add_u32 s14, s14, 16384
    buffer_load_dwordx4 v[104:107], v12, s[56:59], s14 offen offset:0 nt
    buffer_load_dwordx4 v[108:111], v12, s[56:59], s14 offen offset:1024 nt
    s_add_u32 s14, s14, 16384
    buffer_load_dwordx4 v[112:115], v12, s[56:59], s14 offen offset:0 nt
    buffer_load_dwordx4 v[116:119], v12, s[56:59], s14 offen offset:1024 nt
    s_add_u32 s14, s14, 16384
    buffer_load_dwordx4 v[120:123], v12, s[56:59], s14 offen offset:0 nt
    buffer_load_dwordx4 v[124:127], v12, s[56:59], s14 offen offset:1024 nt
    s_add_u32 s14, s14, 16384
    buffer_load_dwordx4 v[128:131], v12, s[56:59], s14 offen offset:0 nt
    buffer_load_dwordx4 v[132:135], v12, s[56:59], s14 offen offset:1024 nt
    s_add_u32 s14, s14, 16384
    buffer_load_dwordx4 v[136:139], v12, s[56:59], s14 offen offset:0 nt
    buffer_load_dwordx4 v[140:143], v12, s[56:59], s14 offen offset:1024 nt
    s_add_u32 s14, s14, 16384
    buffer_load_dwordx4 v[144:147], v12, s[56:59], s14 offen offset:0 nt
    buffer_load_dwordx4 v[148:151], v12, s[56:59], s14 offen offset:1024 nt
    s_add_u32 s14, s14, 16384
    buffer_load_dwordx4 v[152:155], v12, s[56:59], s14 offen offset:0 nt
    buffer_load_dwordx4 v[156:159], v12, s[56:59], s14 offen offset:1024 nt
    s_add_u32 s14, s14, 16384
    buffer_load_dwordx4 v[160:163], v12, s[56:59], s14 offen offset:0 nt
    buffer_load_dwordx4 v[164:167], v12, s[56:59], s14 offen offset:1024 nt
    s_add_u32 s14, s14, 16384
    buffer_load_dwordx4 v[168:171], v12, s[56:59], s14 offen offset:0 nt
    buffer_load_dwordx4 v[172:175], v12, s[56:59], s14 offen offset:1024 nt
    s_mul_i32 s12, s10, 896
    s_add_u32 s12, s12, 131072
    s_add_u32 s13, s12, 8192
    v_min_u32 v13, 55, v0
    v_lshlrev_b32 v13, 4, v13
    s_mov_b64 s[72:73], -1
    s_mov_b64 s[74:75], -1
    s_mov_b32 s90, 65536
L_poll_13:
    s_mov_b64 exec, s[72:73]
    s_cbranch_execz L_sk_14
    buffer_load_dwordx4 v[232:235], v13, s[48:51], s12 offen sc1
L_sk_14:
    s_mov_b64 exec, s[74:75]
    s_cbranch_execz L_sk_15
    buffer_load_dwordx4 v[236:239], v13, s[48:51], s13 offen sc1
L_sk_15:
    s_waitcnt vmcnt(0)
    s_mov_b64 exec, s[72:73]
    v_cmp_ne_u64 vcc, s[88:89], v[234:235]
    s_mov_b64 s[72:73], vcc
    s_mov_b64 exec, s[74:75]
    v_cmp_ne_u64 vcc, s[88:89], v[238:239]
    s_mov_b64 s[74:75], vcc
    s_mov_b64 exec, -1
    s_mov_b64 vcc, s[72:73]
    s_or_b64 vcc, vcc, s[74:75]
    s_cbranch_vccz L_pdone_16
    s_sleep 16
    s_sub_u32 s90, s90, 1
    s_cmp_lg_u32 s90, 0
    s_cbranch_scc1 L_poll_13
L_pdone_16:
    v_lshrrev_b32 v13, 1, v13
    ds_write_b64 v13, v[232:233] offset:12544
    ds_write_b64 v13, v[236:237] offset:13056
    v_mov_b32 v16, 0
    v_mov_b32 v17, 0
    v_mov_b32 v18, 0
    v_mov_b32 v19, 0
    v_mov_b32 v20, 0
    v_mov_b32 v21, 0
    v_mov_b32 v22, 0
    v_mov_b32 v23, 0
    v_mov_b32 v24, 0
    v_mov_b32 v25, 0
    v_mov_b32 v26, 0
    v_mov_b32 v27, 0
    v_mov_b32 v28, 0
    v_mov_b32 v29, 0
    v_mov_b32 v30, 0
    v_mov_b32 v31, 0
    s_waitcnt lgkmcnt(0)
    ds_read_b32 v32, v54 offset:12544
    ds_read_b32 v33, v54 offset:12576
    ds_read_b32 v34, v54 offset:12608
    ds_read_b32 v35, v54 offset:12640
    ds_read_b32 v36, v54 offset:12672
    ds_read_b32 v37, v54 offset:12704
    ds_read_b32 v38, v54 offset:12736
    ds_read_b32 v40, v54 offset:13056
    ds_read_b32 v41, v54 offset:13088
    ds_read_b32 v42, v54 offset:13120
    ds_read_b32 v43, v54 offset:13152
    ds_read_b32 v44, v54 offset:13184
    ds_read_b32 v45, v54 offset:13216
    ds_read_b32 v46, v54 offset:13248
    s_waitcnt lgkmcnt(0)
    v_perm_b32 v12, v68, v64, s80
    v_perm_b32 v13, v68, v64, s81
    v_dot2c_f32_bf16 v16, v12, v32
    v_dot2c_f32_bf16 v17, v13, v32
    v_dot2c_f32_bf16 v24, v12, v40
    v_dot2c_f32_bf16 v25, v13, v40
    v_perm_b32 v12, v69, v65, s80
    v_perm_b32 v13, v69, v65, s81
    v_dot2c_f32_bf16 v18, v12, v32
    v_dot2c_f32_bf16 v19, v13, v32
    v_dot2c_f32_bf16 v26, v12, v40
    v_dot2c_f32_bf16 v27, v13, v40
    v_perm_b32 v12, v70, v66, s80
    v_perm_b32 v13, v70, v66, s81
    v_dot2c_f32_bf16 v20, v12, v32
    v_dot2c_f32_bf16 v21, v13, v32
    v_dot2c_f32_bf16 v28, v12, v40
    v_dot2c_f32_bf16 v29, v13, v40
    v_perm_b32 v12, v71, v67, s80
    v_perm_b32 v13, v71, v67, s81
    v_dot2c_f32_bf16 v22, v12, v32
    v_dot2c_f32_bf16 v23, v13, v32
    v_dot2c_f32_bf16 v30, v12, v40
    v_dot2c_f32_bf16 v31, v13, v40
    v_perm_b32 v12, v76, v72, s80
    v_perm_b32 v13, v76, v72, s81
    v_dot2c_f32_bf16 v16, v12, v33
    v_dot2c_f32_bf16 v17, v13, v33
    v_dot2c_f32_bf16 v24, v12, v41
    v_dot2c_f32_bf16 v25, v13, v41
    v_perm_b32 v12, v77, v73, s80
    v_perm_b32 v13, v77, v73, s81
    v_dot2c_f32_bf16 v18, v12, v33
    v_dot2c_f32_bf16 v19, v13, v33
    v_dot2c_f32_bf16 v26, v12, v41
    v_dot2c_f32_bf16 v27, v13, v41
    v_perm_b32 v12, v78, v74, s80
    v_perm_b32 v13, v78, v74, s81
    v_dot2c_f32_bf16 v20, v12, v33
    v_dot2c_f32_bf16 v21, v13, v33
    v_dot2c_f32_bf16 v28, v12, v41
    v_dot2c_f32_bf16 v29, v13, v41
    v_perm_b32 v12, v79, v75, s80
    v_perm_b32 v13, v79, v75, s81
    v_dot2c_f32_bf16 v22, v12, v33
    v_dot2c_f32_bf16 v23, v13, v33
    v_dot2c_f32_bf16 v30, v12, v41
    v_dot2c_f32_bf16 v31, v13, v41
    v_perm_b32 v12, v84, v80, s80
    v_perm_b32 v13, v84, v80, s81
    v_dot2c_f32_bf16 v16, v12, v34
    v_dot2c_f32_bf16 v17, v13, v34
    v_dot2c_f32_bf16 v24, v12, v42
    v_dot2c_f32_bf16 v25, v13, v42
    v_perm_b32 v12, v85, v81, s80
    v_perm_b32 v13, v85, v81, s81
    v_dot2c_f32_bf16 v18, v12, v34
    v_dot2c_f32_bf16 v19, v13, v34
    v_dot2c_f32_bf16 v26, v12, v42
    v_dot2c_f32_bf16 v27, v13, v42
    v_perm_b32 v12, v86, v82, s80
    v_perm_b32 v13, v86, v82, s81
    v_dot2c_f32_bf16 v20, v12, v34
    v_dot2c_f32_bf16 v21, v13, v34
    v_dot2c_f32_bf16 v28, v12, v42
    v_dot2c_f32_bf16 v29, v13, v42
    v_perm_b32 v12, v87, v83, s80
    v_perm_b32 v13, v87, v83, s81
    v_dot2c_f32_bf16 v22, v12, v34
    v_dot2c_f32_bf16 v23, v13, v34
    v_dot2c_f32_bf16 v30, v12, v42
    v_dot2c_f32_bf16 v31, v13, v42
    v_perm_b32 v12, v92, v88, s80
    v_perm_b32 v13, v92, v88, s81
    v_dot2c_f32_bf16 v16, v12, v35
    v_dot2c_f32_bf16 v17, v13, v35
    v_dot2c_f32_bf16 v24, v12, v43
    v_dot2c_f32_bf16 v25, v13, v43
    v_perm_b32 v12, v93, v89, s80
    v_perm_b32 v13, v93, v89, s81
    v_dot2c_f32_bf16 v18, v12, v35
    v_dot2c_f32_bf16 v19, v13, v35
    v_dot2c_f32_bf16 v26, v12, v43
    v_dot2c_f32_bf16 v27, v13, v43
    v_perm_b32 v12, v94, v90, s80
    v_perm_b32 v13, v94, v90, s81
    v_dot2c_f32_bf16 v20, v12, v35
    v_dot2c_f32_bf16 v21, v13, v35
    v_dot2c_f32_bf16 v28, v12, v43
    v_dot2c_f32_bf16 v29, v13, v43
    v_perm_b32 v12, v95, v91, s80
    v_perm_b32 v13, v95, v91, s81
    v_dot2c_f32_bf16 v22, v12, v35
    v_dot2c_f32_bf16 v23, v13, v35
    v_dot2c_f32_bf16 v30, v12, v43
    v_dot2c_f32_bf16 v31, v13, v43
    v_perm_b32 v12, v100, v96, s80
    v_perm_b32 v13, v100, v96, s81
    v_dot2c_f32_bf16 v16, v12, v36
    v_dot2c_f32_bf16 v17, v13, v36
    v_dot2c_f32_bf16 v24, v12, v44
    v_dot2c_f32_bf16 v25, v13, v44
    v_perm_b32 v12, v101, v97, s80
    v_perm_b32 v13, v101, v97, s81
    v_dot2c_f32_bf16 v18, v12, v36
    v_dot2c_f32_bf16 v19, v13, v36
    v_dot2c_f32_bf16 v26, v12, v44
    v_dot2c_f32_bf16 v27, v13, v44
    v_perm_b32 v12, v102, v98, s80
    v_perm_b32 v13, v102, v98, s81
    v_dot2c_f32_bf16 v20, v12, v36
    v_dot2c_f32_bf16 v21, v13, v36
    v_dot2c_f32_bf16 v28, v12, v44
    v_dot2c_f32_bf16 v29, v13, v44
    v_perm_b32 v12, v103, v99, s80
    v_perm_b32 v13, v103, v99, s81
    v_dot2c_f32_bf16 v22, v12, v36
    v_dot2c_f32_bf16 v23, v13, v36
    v_dot2c_f32_bf16 v30, v12, v44
    v_dot2c_f32_bf16 v31, v13, v44
    v_perm_b32 v12, v108, v104, s80
    v_perm_b32 v13, v108, v104, s81
    v_dot2c_f32_bf16 v16, v12, v37
    v_dot2c_f32_bf16 v17, v13, v37
    v_dot2c_f32_bf16 v24, v12, v45
    v_dot2c_f32_bf16 v25, v13, v45
    v_perm_b32 v12, v109, v105, s80
    v_perm_b32 v13, v109, v105, s81
    v_dot2c_f32_bf16 v18, v12, v37
    v_dot2c_f32_bf16 v19, v13, v37
    v_dot2c_f32_bf16 v26, v12, v45
    v_dot2c_f32_bf16 v27, v13, v45
    v_perm_b32 v12, v110, v106, s80
    v_perm_b32 v13, v110, v106, s81
    v_dot2c_f32_bf16 v20, v12, v37
    v_dot2c_f32_bf16 v21, v13, v37
    v_dot2c_f32_bf16 v28, v12, v45
    v_dot2c_f32_bf16 v29, v13, v45
    v_perm_b32 v12, v111, v107, s80
    v_perm_b32 v13, v111, v107, s81
    v_dot2c_f32_bf16 v22, v12, v37
    v_dot2c_f32_bf16 v23, v13, v37
    v_dot2c_f32_bf16 v30, v12, v45
    v_dot2c_f32_bf16 v31, v13, v45
    v_perm_b32 v12, v116, v112, s80
    v_perm_b32 v13, v116, v112, s81
    v_dot2c_f32_bf16 v16, v12, v38
    v_dot2c_f32_bf16 v17, v13, v38
    v_dot2c_f32_bf16 v24, v12, v46
    v_dot2c_f32_bf16 v25, v13, v46
    v_perm_b32 v12, v117, v113, s80
    v_perm_b32 v13, v117, v113, s81
    v_dot2c_f32_bf16 v18, v12, v38
    v_dot2c_f32_bf16 v19, v13, v38
    v_dot2c_f32_bf16 v26, v12, v46
    v_dot2c_f32_bf16 v27, v13, v46
    v_perm_b32 v12, v118, v114, s80
    v_perm_b32 v13, v118, v114, s81
    v_dot2c_f32_bf16 v20, v12, v38
    v_dot2c_f32_bf16 v21, v13, v38
    v_dot2c_f32_bf16 v28, v12, v46
    v_dot2c_f32_bf16 v29, v13, v46
    v_perm_b32 v12, v119, v115, s80
    v_perm_b32 v13, v119, v115, s81
    v_dot2c_f32_bf16 v22, v12, v38
    v_dot2c_f32_bf16 v23, v13, v38
    v_dot2c_f32_bf16 v30, v12, v46
    v_dot2c_f32_bf16 v31, v13, v46
    ds_read_b32 v32, v54 offset:12768
    ds_read_b32 v33, v54 offset:12800
    ds_read_b32 v34, v54 offset:12832
    ds_read_b32 v35, v54 offset:12864
    ds_read_b32 v36, v54 offset:12896
    ds_read_b32 v37, v54 offset:12928
    ds_read_b32 v38, v54 offset:12960
    ds_read_b32 v40, v54 offset:13280
    ds_read_b32 v41, v54 offset:13312
    ds_read_b32 v42, v54 offset:13344
    ds_read_b32 v43, v54 offset:13376
    ds_read_b32 v44, v54 offset:13408
    ds_read_b32 v45, v54 offset:13440
    ds_read_b32 v46, v54 offset:13472
    s_waitcnt lgkmcnt(0)
    v_perm_b32 v12, v124, v120, s80
    v_perm_b32 v13, v124, v120, s81
    v_dot2c_f32_bf16 v16, v12, v32
    v_dot2c_f32_bf16 v17, v13, v32
    v_dot2c_f32_bf16 v24, v12, v40
    v_dot2c_f32_bf16 v25, v13, v40
    v_perm_b32 v12, v125, v121, s80
    v_perm_b32 v13, v125, v121, s81
    v_dot2c_f32_bf16 v18, v12, v32
    v_dot2c_f32_bf16 v19, v13, v32
    v_dot2c_f32_bf16 v26, v12, v40
    v_dot2c_f32_bf16 v27, v13, v40
    v_perm_b32 v12, v126, v122, s80
    v_perm_b32 v13, v126, v122, s81
    v_dot2c_f32_bf16 v20, v12, v32
    v_dot2c_f32_bf16 v21, v13, v32
    v_dot2c_f32_bf16 v28, v12, v40
    v_dot2c_f32_bf16 v29, v13, v40
    v_perm_b32 v12, v127, v123, s80
    v_perm_b32 v13, v127, v123, s81
    v_dot2c_f32_bf16 v22, v12, v32
    v_dot2c_f32_bf16 v23, v13, v32
    v_dot2c_f32_bf16 v30, v12, v40
    v_dot2c_f32_bf16 v31, v13, v40
    v_perm_b32 v12, v132, v128, s80
    v_perm_b32 v13, v132, v128, s81
    v_dot2c_f32_bf16 v16, v12, v33
    v_dot2c_f32_bf16 v17, v13, v33
    v_dot2c_f32_bf16 v24, v12, v41
    v_dot2c_f32_bf16 v25, v13, v41
    v_perm_b32 v12, v133, v129, s80
    v_perm_b32 v13, v133, v129, s81
    v_dot2c_f32_bf16 v18, v12, v33
    v_dot2c_f32_bf16 v19, v13, v33
    v_dot2c_f32_bf16 v26, v12, v41
    v_dot2c_f32_bf16 v27, v13, v41
    v_perm_b32 v12, v134, v130, s80
    v_perm_b32 v13, v134, v130, s81
    v_dot2c_f32_bf16 v20, v12, v33
    v_dot2c_f32_bf16 v21, v13, v33
    v_dot2c_f32_bf16 v28, v12, v41
    v_dot2c_f32_bf16 v29, v13, v41
    v_perm_b32 v12, v135, v131, s80
    v_perm_b32 v13, v135, v131, s81
    v_dot2c_f32_bf16 v22, v12, v33
    v_dot2c_f32_bf16 v23, v13, v33
    v_dot2c_f32_bf16 v30, v12, v41
    v_dot2c_f32_bf16 v31, v13, v41
    v_perm_b32 v12, v140, v136, s80
    v_perm_b32 v13, v140, v136, s81
    v_dot2c_f32_bf16 v16, v12, v34
    v_dot2c_f32_bf16 v17, v13, v34
    v_dot2c_f32_bf16 v24, v12, v42
    v_dot2c_f32_bf16 v25, v13, v42
    v_perm_b32 v12, v141, v137, s80
    v_perm_b32 v13, v141, v137, s81
    v_dot2c_f32_bf16 v18, v12, v34
    v_dot2c_f32_bf16 v19, v13, v34
    v_dot2c_f32_bf16 v26, v12, v42
    v_dot2c_f32_bf16 v27, v13, v42
    v_perm_b32 v12, v142, v138, s80
    v_perm_b32 v13, v142, v138, s81
    v_dot2c_f32_bf16 v20, v12, v34
    v_dot2c_f32_bf16 v21, v13, v34
    v_dot2c_f32_bf16 v28, v12, v42
    v_dot2c_f32_bf16 v29, v13, v42
    v_perm_b32 v12, v143, v139, s80
    v_perm_b32 v13, v143, v139, s81
    v_dot2c_f32_bf16 v22, v12, v34
    v_dot2c_f32_bf16 v23, v13, v34
    v_dot2c_f32_bf16 v30, v12, v42
    v_dot2c_f32_bf16 v31, v13, v42
    v_perm_b32 v12, v148, v144, s80
    v_perm_b32 v13, v148, v144, s81
    v_dot2c_f32_bf16 v16, v12, v35
    v_dot2c_f32_bf16 v17, v13, v35
    v_dot2c_f32_bf16 v24, v12, v43
    v_dot2c_f32_bf16 v25, v13, v43
    v_perm_b32 v12, v149, v145, s80
    v_perm_b32 v13, v149, v145, s81
    v_dot2c_f32_bf16 v18, v12, v35
    v_dot2c_f32_bf16 v19, v13, v35
    v_dot2c_f32_bf16 v26, v12, v43
    v_dot2c_f32_bf16 v27, v13, v43
    v_perm_b32 v12, v150, v146, s80
    v_perm_b32 v13, v150, v146, s81
    v_dot2c_f32_bf16 v20, v12, v35
    v_dot2c_f32_bf16 v21, v13, v35
    v_dot2c_f32_bf16 v28, v12, v43
    v_dot2c_f32_bf16 v29, v13, v43
    v_perm_b32 v12, v151, v147, s80
    v_perm_b32 v13, v151, v147, s81
    v_dot2c_f32_bf16 v22, v12, v35
    v_dot2c_f32_bf16 v23, v13, v35
    v_dot2c_f32_bf16 v30, v12, v43
    v_dot2c_f32_bf16 v31, v13, v43
    v_perm_b32 v12, v156, v152, s80
    v_perm_b32 v13, v156, v152, s81
    v_dot2c_f32_bf16 v16, v12, v36
    v_dot2c_f32_bf16 v17, v13, v36
    v_dot2c_f32_bf16 v24, v12, v44
    v_dot2c_f32_bf16 v25, v13, v44
    v_perm_b32 v12, v157, v153, s80
    v_perm_b32 v13, v157, v153, s81
    v_dot2c_f32_bf16 v18, v12, v36
    v_dot2c_f32_bf16 v19, v13, v36
    v_dot2c_f32_bf16 v26, v12, v44
    v_dot2c_f32_bf16 v27, v13, v44
    v_perm_b32 v12, v158, v154, s80
    v_perm_b32 v13, v158, v154, s81
    v_dot2c_f32_bf16 v20, v12, v36
    v_dot2c_f32_bf16 v21, v13, v36
    v_dot2c_f32_bf16 v28, v12, v44
    v_dot2c_f32_bf16 v29, v13, v44
    v_perm_b32 v12, v159, v155, s80
    v_perm_b32 v13, v159, v155, s81
    v_dot2c_f32_bf16 v22, v12, v36
    v_dot2c_f32_bf16 v23, v13, v36
    v_dot2c_f32_bf16 v30, v12, v44
    v_dot2c_f32_bf16 v31, v13, v44
    v_perm_b32 v12, v164, v160, s80
    v_perm_b32 v13, v164, v160, s81
    v_dot2c_f32_bf16 v16, v12, v37
    v_dot2c_f32_bf16 v17, v13, v37
    v_dot2c_f32_bf16 v24, v12, v45
    v_dot2c_f32_bf16 v25, v13, v45
    v_perm_b32 v12, v165, v161, s80
    v_perm_b32 v13, v165, v161, s81
    v_dot2c_f32_bf16 v18, v12, v37
    v_dot2c_f32_bf16 v19, v13, v37
    v_dot2c_f32_bf16 v26, v12, v45
    v_dot2c_f32_bf16 v27, v13, v45
    v_perm_b32 v12, v166, v162, s80
    v_perm_b32 v13, v166, v162, s81
    v_dot2c_f32_bf16 v20, v12, v37
    v_dot2c_f32_bf16 v21, v13, v37
    v_dot2c_f32_bf16 v28, v12, v45
    v_dot2c_f32_bf16 v29, v13, v45
    v_perm_b32 v12, v167, v163, s80
    v_perm_b32 v13, v167, v163, s81
    v_dot2c_f32_bf16 v22, v12, v37
    v_dot2c_f32_bf16 v23, v13, v37
    v_dot2c_f32_bf16 v30, v12, v45
    v_dot2c_f32_bf16 v31, v13, v45
    v_perm_b32 v12, v172, v168, s80
    v_perm_b32 v13, v172, v168, s81
    v_dot2c_f32_bf16 v16, v12, v38
    v_dot2c_f32_bf16 v17, v13, v38
    v_dot2c_f32_bf16 v24, v12, v46
    v_dot2c_f32_bf16 v25, v13, v46
    v_perm_b32 v12, v173, v169, s80
    v_perm_b32 v13, v173, v169, s81
    v_dot2c_f32_bf16 v18, v12, v38
    v_dot2c_f32_bf16 v19, v13, v38
    v_dot2c_f32_bf16 v26, v12, v46
    v_dot2c_f32_bf16 v27, v13, v46
    v_perm_b32 v12, v174, v170, s80
    v_perm_b32 v13, v174, v170, s81
    v_dot2c_f32_bf16 v20, v12, v38
    v_dot2c_f32_bf16 v21, v13, v38
    v_dot2c_f32_bf16 v28, v12, v46
    v_dot2c_f32_bf16 v29, v13, v46
    v_perm_b32 v12, v175, v171, s80
    v_perm_b32 v13, v175, v171, s81
    v_dot2c_f32_bf16 v22, v12, v38
    v_dot2c_f32_bf16 v23, v13, v38
    v_dot2c_f32_bf16 v30, v12, v46
    v_dot2c_f32_bf16 v31, v13, v46
    s_nop 2
    v_permlane32_swap_b32 v16, v24
    v_permlane32_swap_b32 v17, v25
    v_permlane32_swap_b32 v18, v26
    v_permlane32_swap_b32 v19, v27
    v_permlane32_swap_b32 v20, v28
    v_permlane32_swap_b32 v21, v29
    v_permlane32_swap_b32 v22, v30
    v_permlane32_swap_b32 v23, v31
    s_nop 0
    v_add_f32 v16, v16, v24
    v_add_f32 v17, v17, v25
    v_add_f32 v18, v18, v26
    v_add_f32 v19, v19, v27
    v_add_f32 v20, v20, v28
    v_add_f32 v21, v21, v29
    v_add_f32 v22, v22, v30
    v_add_f32 v23, v23, v31
    s_nop 1
    v_permlane16_swap_b32 v16, v20
    v_permlane16_swap_b32 v17, v21
    v_permlane16_swap_b32 v18, v22
    v_permlane16_swap_b32 v19, v23
    s_nop 0
    v_add_f32 v16, v16, v20
    v_add_f32 v17, v17, v21
    v_add_f32 v18, v18, v22
    v_add_f32 v19, v19, v23
    s_nop 1
    v_add_f32_dpp v16, v16, v16 row_ror:8 row_mask:0xf bank_mask:0xf
    v_add_f32_dpp v17, v17, v17 row_ror:8 row_mask:0xf bank_mask:0xf
    v_add_f32_dpp v18, v18, v18 row_ror:8 row_mask:0xf bank_mask:0xf
    v_add_f32_dpp v19, v19, v19 row_ror:8 row_mask:0xf bank_mask:0xf
    v_lshl_add_u32 v13, v3, 9, v52
    s_lshl_b32 s12, s11, 13
    s_lshl_b32 s13, s10, 10
    s_add_u32 s12, s12, s13
    s_add_u32 s12, s12, 294912
    v_mov_b32 v4, v16
    v_mov_b32 v5, v17
    v_mov_b32 v8, v18
    v_mov_b32 v9, v19
    s_mov_b64 exec, s[76:77]
    buffer_store_dwordx4 v[4:7], v13, s[48:51], s12 offen sc1
    buffer_store_dwordx4 v[8:11], v13, s[48:51], s12 offen offset:256 sc1
    s_mov_b64 exec, -1
L_nohc:
    s_lshl_b32 s14, s4, 19
    s_lshl_b32 s15, s6, 15
    s_add_u32 s14, s14, s15
    buffer_load_dwordx4 v[128:131], v1, s[60:63], s14 offen offset:0 nt
    buffer_load_dwordx4 v[132:135], v1, s[60:63], s14 offen offset:1024 nt
    buffer_load_dwordx4 v[136:139], v1, s[60:63], s14 offen offset:2048 nt
    buffer_load_dwordx4 v[140:143], v1, s[60:63], s14 offen offset:3072 nt
    s_add_u32 s14, s14, 4096
    buffer_load_dwordx4 v[144:147], v1, s[60:63], s14 offen offset:0 nt
    buffer_load_dwordx4 v[148:151], v1, s[60:63], s14 offen offset:1024 nt
    buffer_load_dwordx4 v[152:155], v1, s[60:63], s14 offen offset:2048 nt
    buffer_load_dwordx4 v[156:159], v1, s[60:63], s14 offen offset:3072 nt
    s_add_u32 s14, s14, 4096
    buffer_load_dwordx4 v[160:163], v1, s[60:63], s14 offen offset:0 nt
    buffer_load_dwordx4 v[164:167], v1, s[60:63], s14 offen offset:1024 nt
    buffer_load_dwordx4 v[168:171], v1, s[60:63], s14 offen offset:2048 nt
    buffer_load_dwordx4 v[172:175], v1, s[60:63], s14 offen offset:3072 nt
    s_add_u32 s14, s14, 4096
    buffer_load_dwordx4 v[176:179], v1, s[60:63], s14 offen offset:0 nt
    buffer_load_dwordx4 v[180:183], v1, s[60:63], s14 offen offset:1024 nt
    buffer_load_dwordx4 v[184:187], v1, s[60:63], s14 offen offset:2048 nt
    buffer_load_dwordx4 v[188:191], v1, s[60:63], s14 offen offset:3072 nt
    s_add_u32 s14, s14, 4096
    buffer_load_dwordx4 v[192:195], v1, s[60:63], s14 offen offset:0 nt
    buffer_load_dwordx4 v[196:199], v1, s[60:63], s14 offen offset:1024 nt
    buffer_load_dwordx4 v[200:203], v1, s[60:63], s14 offen offset:2048 nt
    buffer_load_dwordx4 v[204:207], v1, s[60:63], s14 offen offset:3072 nt
    s_add_u32 s14, s14, 4096
    buffer_load_dwordx4 v[208:211], v1, s[60:63], s14 offen offset:0 nt
    buffer_load_dwordx4 v[212:215], v1, s[60:63], s14 offen offset:1024 nt
    buffer_load_dwordx4 v[216:219], v1, s[60:63], s14 offen offset:2048 nt
    buffer_load_dwordx4 v[220:223], v1, s[60:63], s14 offen offset:3072 nt
    s_add_u32 s14, s14, 4096
    buffer_load_dwordx4 v[224:227], v1, s[60:63], s14 offen offset:0 nt
    buffer_load_dwordx4 v[228:231], v1, s[60:63], s14 offen offset:1024 nt
    buffer_load_dwordx4 v[232:235], v1, s[60:63], s14 offen offset:2048 nt
    buffer_load_dwordx4 v[236:239], v1, s[60:63], s14 offen offset:3072 nt
    s_add_u32 s14, s14, 4096
    buffer_load_dwordx4 v[240:243], v1, s[60:63], s14 offen offset:0 nt
    buffer_load_dwordx4 v[244:247], v1, s[60:63], s14 offen offset:1024 nt
    buffer_load_dwordx4 v[248:251], v1, s[60:63], s14 offen offset:2048 nt
    buffer_load_dwordx4 v[252:255], v1, s[60:63], s14 offen offset:3072 nt
    s_add_u32 s14, s14, 4096
    s_waitcnt vmcnt(0)
    v_perm_b32 v12, v132, v128, s80
    v_perm_b32 v132, v132, v128, s81
    v_mov_b32 v128, v12
    v_perm_b32 v12, v133, v129, s80
    v_perm_b32 v133, v133, v129, s81
    v_mov_b32 v129, v12
    v_perm_b32 v12, v134, v130, s80
    v_perm_b32 v134, v134, v130, s81
    v_mov_b32 v130, v12
    v_perm_b32 v12, v135, v131, s80
    v_perm_b32 v135, v135, v131, s81
    v_mov_b32 v131, v12
    v_perm_b32 v12, v140, v136, s80
    v_perm_b32 v140, v140, v136, s81
    v_mov_b32 v136, v12
    v_perm_b32 v12, v141, v137, s80
    v_perm_b32 v141, v141, v137, s81
    v_mov_b32 v137, v12
    v_perm_b32 v12, v142, v138, s80
    v_perm_b32 v142, v142, v138, s81
    v_mov_b32 v138, v12
    v_perm_b32 v12, v143, v139, s80
    v_perm_b32 v143, v143, v139, s81
    v_mov_b32 v139, v12
    v_perm_b32 v12, v148, v144, s80
    v_perm_b32 v148, v148, v144, s81
    v_mov_b32 v144, v12
    v_perm_b32 v12, v149, v145, s80
    v_perm_b32 v149, v149, v145, s81
    v_mov_b32 v145, v12
    v_perm_b32 v12, v150, v146, s80
    v_perm_b32 v150, v150, v146, s81
    v_mov_b32 v146, v12
    v_perm_b32 v12, v151, v147, s80
    v_perm_b32 v151, v151, v147, s81
    v_mov_b32 v147, v12
    v_perm_b32 v12, v156, v152, s80
    v_perm_b32 v156, v156, v152, s81
    v_mov_b32 v152, v12
    v_perm_b32 v12, v157, v153, s80
    v_perm_b32 v157, v157, v153, s81
    v_mov_b32 v153, v12
    v_perm_b32 v12, v158, v154, s80
    v_perm_b32 v158, v158, v154, s81
    v_mov_b32 v154, v12
    v_perm_b32 v12, v159, v155, s80
    v_perm_b32 v159, v159, v155, s81
    v_mov_b32 v155, v12
    v_perm_b32 v12, v164, v160, s80
    v_perm_b32 v164, v164, v160, s81
    v_mov_b32 v160, v12
    v_perm_b32 v12, v165, v161, s80
    v_perm_b32 v165, v165, v161, s81
    v_mov_b32 v161, v12
    v_perm_b32 v12, v166, v162, s80
    v_perm_b32 v166, v166, v162, s81
    v_mov_b32 v162, v12
    v_perm_b32 v12, v167, v163, s80
    v_perm_b32 v167, v167, v163, s81
    v_mov_b32 v163, v12
    v_perm_b32 v12, v172, v168, s80
    v_perm_b32 v172, v172, v168, s81
    v_mov_b32 v168, v12
    v_perm_b32 v12, v173, v169, s80
    v_perm_b32 v173, v173, v169, s81
    v_mov_b32 v169, v12
    v_perm_b32 v12, v174, v170, s80
    v_perm_b32 v174, v174, v170, s81
    v_mov_b32 v170, v12
    v_perm_b32 v12, v175, v171, s80
    v_perm_b32 v175, v175, v171, s81
    v_mov_b32 v171, v12
    v_perm_b32 v12, v180, v176, s80
    v_perm_b32 v180, v180, v176, s81
    v_mov_b32 v176, v12
    v_perm_b32 v12, v181, v177, s80
    v_perm_b32 v181, v181, v177, s81
    v_mov_b32 v177, v12
    v_perm_b32 v12, v182, v178, s80
    v_perm_b32 v182, v182, v178, s81
    v_mov_b32 v178, v12
    v_perm_b32 v12, v183, v179, s80
    v_perm_b32 v183, v183, v179, s81
    v_mov_b32 v179, v12
    v_perm_b32 v12, v188, v184, s80
    v_perm_b32 v188, v188, v184, s81
    v_mov_b32 v184, v12
    v_perm_b32 v12, v189, v185, s80
    v_perm_b32 v189, v189, v185, s81
    v_mov_b32 v185, v12
    v_perm_b32 v12, v190, v186, s80
    v_perm_b32 v190, v190, v186, s81
    v_mov_b32 v186, v12
    v_perm_b32 v12, v191, v187, s80
    v_perm_b32 v191, v191, v187, s81
    v_mov_b32 v187, v12
    v_perm_b32 v12, v196, v192, s80
    v_perm_b32 v196, v196, v192, s81
    v_mov_b32 v192, v12
    v_perm_b32 v12, v197, v193, s80
    v_perm_b32 v197, v197, v193, s81
    v_mov_b32 v193, v12
    v_perm_b32 v12, v198, v194, s80
    v_perm_b32 v198, v198, v194, s81
    v_mov_b32 v194, v12
    v_perm_b32 v12, v199, v195, s80
    v_perm_b32 v199, v199, v195, s81
    v_mov_b32 v195, v12
    v_perm_b32 v12, v204, v200, s80
    v_perm_b32 v204, v204, v200, s81
    v_mov_b32 v200, v12
    v_perm_b32 v12, v205, v201, s80
    v_perm_b32 v205, v205, v201, s81
    v_mov_b32 v201, v12
    v_perm_b32 v12, v206, v202, s80
    v_perm_b32 v206, v206, v202, s81
    v_mov_b32 v202, v12
    v_perm_b32 v12, v207, v203, s80
    v_perm_b32 v207, v207, v203, s81
    v_mov_b32 v203, v12
    v_perm_b32 v12, v212, v208, s80
    v_perm_b32 v212, v212, v208, s81
    v_mov_b32 v208, v12
    v_perm_b32 v12, v213, v209, s80
    v_perm_b32 v213, v213, v209, s81
    v_mov_b32 v209, v12
    v_perm_b32 v12, v214, v210, s80
    v_perm_b32 v214, v214, v210, s81
    v_mov_b32 v210, v12
    v_perm_b32 v12, v215, v211, s80
    v_perm_b32 v215, v215, v211, s81
    v_mov_b32 v211, v12
    v_perm_b32 v12, v220, v216, s80
    v_perm_b32 v220, v220, v216, s81
    v_mov_b32 v216, v12
    v_perm_b32 v12, v221, v217, s80
    v_perm_b32 v221, v221, v217, s81
    v_mov_b32 v217, v12
    v_perm_b32 v12, v222, v218, s80
    v_perm_b32 v222, v222, v218, s81
    v_mov_b32 v218, v12
    v_perm_b32 v12, v223, v219, s80
    v_perm_b32 v223, v223, v219, s81
    v_mov_b32 v219, v12
    v_perm_b32 v12, v228, v224, s80
    v_perm_b32 v228, v228, v224, s81
    v_mov_b32 v224, v12
    v_perm_b32 v12, v229, v225, s80
    v_perm_b32 v229, v229, v225, s81
    v_mov_b32 v225, v12
    v_perm_b32 v12, v230, v226, s80
    v_perm_b32 v230, v230, v226, s81
    v_mov_b32 v226, v12
    v_perm_b32 v12, v231, v227, s80
    v_perm_b32 v231, v231, v227, s81
    v_mov_b32 v227, v12
    v_perm_b32 v12, v236, v232, s80
    v_perm_b32 v236, v236, v232, s81
    v_mov_b32 v232, v12
    v_perm_b32 v12, v237, v233, s80
    v_perm_b32 v237, v237, v233, s81
    v_mov_b32 v233, v12
    v_perm_b32 v12, v238, v234, s80
    v_perm_b32 v238, v238, v234, s81
    v_mov_b32 v234, v12
    v_perm_b32 v12, v239, v235, s80
    v_perm_b32 v239, v239, v235, s81
    v_mov_b32 v235, v12
    v_perm_b32 v12, v244, v240, s80
    v_perm_b32 v244, v244, v240, s81
    v_mov_b32 v240, v12
    v_perm_b32 v12, v245, v241, s80
    v_perm_b32 v245, v245, v241, s81
    v_mov_b32 v241, v12
    v_perm_b32 v12, v246, v242, s80
    v_perm_b32 v246, v246, v242, s81
    v_mov_b32 v242, v12
    v_perm_b32 v12, v247, v243, s80
    v_perm_b32 v247, v247, v243, s81
    v_mov_b32 v243, v12
    v_perm_b32 v12, v252, v248, s80
    v_perm_b32 v252, v252, v248, s81
    v_mov_b32 v248, v12
    v_perm_b32 v12, v253, v249, s80
    v_perm_b32 v253, v253, v249, s81
    v_mov_b32 v249, v12
    v_perm_b32 v12, v254, v250, s80
    v_perm_b32 v254, v254, v250, s81
    v_mov_b32 v250, v12
    v_perm_b32 v12, v255, v251, s80
    v_perm_b32 v255, v255, v251, s81
    v_mov_b32 v251, v12
    v_bfe_u32 v12, v0, 2, 1
    v_lshlrev_b32 v13, 10, v12
    v_and_b32 v12, 3, v0
    v_lshl_add_u32 v58, v12, 2, v13
    s_lshl_b32 s85, s8, 2
    s_add_u32 s85, s85, s6
    s_sub_u32 s85, s85, 4
    s_lshr_b32 s91, s6, 2
    s_cmp_lg_u32 s91, 1
    s_cbranch_scc1 L_nof2
    s_lshl_b32 s12, s85, 4
    buffer_load_dword v60, v58, s[40:43], s12 offen
    v_lshrrev_b32 v13, 2, v0
    v_lshlrev_b32 v13, 9, v13
    v_and_b32 v12, 1, v0
    v_lshl_add_u32 v13, v12, 8, v13
    v_bfe_u32 v12, v0, 1, 1
    v_lshl_add_u32 v12, v12, 7, v13
    s_lshr_b32 s12, s85, 3
    s_lshl_b32 s12, s12, 13
    s_and_b32 s13, s85, 7
    s_lshl_b32 s13, s13, 4
    s_add_u32 s12, s12, s13
    s_add_u32 s12, s12, 294912
    s_mov_b32 s90, 65536
L_poll_17:
    buffer_load_dwordx4 v[64:67], v12, s[48:51], s12 offen sc1
    s_waitcnt vmcnt(0)
    v_cmp_ne_u64 vcc, s[88:89], v[66:67]
    s_cbranch_vccz L_pdone_18
    s_sleep 32
    s_sub_u32 s90, s90, 1
    s_cmp_lg_u32 s90, 0
    s_cbranch_scc1 L_poll_17
L_pdone_18:
    s_nop 1
    v_add_f32_dpp v64, v64, v64 row_ror:8 row_mask:0xf bank_mask:0xf
    v_add_f32_dpp v65, v65, v65 row_ror:8 row_mask:0xf bank_mask:0xf
    v_mov_b32 v66, v64
    v_mov_b32 v67, v65
    s_nop 1
    v_permlane16_swap_b32 v64, v66
    v_permlane16_swap_b32 v65, v67
    s_nop 0
    v_add_f32 v64, v64, v66
    v_add_f32 v65, v65, v67
    v_mov_b32 v66, v64
    v_mov_b32 v67, v65
    s_nop 1
    v_permlane32_swap_b32 v64, v66
    v_permlane32_swap_b32 v65, v67
    s_nop 0
    v_add_f32 v64, v64, v66
    v_add_f32 v65, v65, v67
    v_cvt_pk_bf16_f32 v64, v64, v64
    v_and_b32 v64, 0xffff0000, v64
    v_mul_f32 v12, s83, v64
    v_exp_f32 v12, v12
    s_nop 0
    v_add_f32 v12, 1.0, v12
    v_rcp_f32 v12, v12
    s_nop 0
    v_mul_f32 v64, v64, v12
    v_cvt_pk_bf16_f32 v52, v64, v64
    v_and_b32 v52, 0xffff0000, v52
    v_cvt_pk_bf16_f32 v65, v65, v65
    v_and_b32 v65, 0xffff0000, v65
    v_mul_f32 v12, s83, v65
    v_exp_f32 v12, v12
    s_nop 0
    v_add_f32 v12, 1.0, v12
    v_rcp_f32 v12, v12
    s_nop 0
    v_mul_f32 v65, v65, v12
    v_cvt_pk_bf16_f32 v53, v65, v65
    v_and_b32 v53, 0xffff0000, v53
    v_lshlrev_b32 v56, 16, v60
    v_and_b32 v57, 0xffff0000, v60
L_nof2:
    v_and_b32 v12, 15, v0
    v_lshlrev_b32 v4, 3, v0
    v_mov_b32 v5, 0
    v_lshlrev_b32 v6, 4, v12
    v_lshl_add_u32 v6, v2, 16, v6
    v_lshlrev_b32 v7, 16, v12
    v_bfe_u32 v13, v0, 2, 2
    v_cmp_eq_u32 s[22:23], 1, v13
    v_cmp_eq_u32 s[24:25], 2, v13
    v_cmp_eq_u32 s[26:27], 3, v13
    s_lshl_b32 s10, s7, 20
    s_lshl_b32 s15, s4, 13
    s_add_u32 s10, s10, s15
    s_add_u32 s10, s10, 1048576
    s_lshl_b32 s15, s6, 4
    s_add_u32 s9, s10, s15
    s_add_u32 s9, s9, 4096
    s_lshl_b32 s15, s6, 8
    s_add_u32 s10, s10, s15
    s_add_u32 s17, s10, 262144
    s_add_u32 s18, s10, 524288
    s_add_u32 s19, s10, 786432
    s_lshl_b32 s14, s2, 13
    s_add_u32 s14, s14, 1048576
    s_add_u32 s15, s14, 4096
    v_lshlrev_b32 v8, 4, v2
    v_lshrrev_b32 v13, 2, v0
    v_and_b32 v10, 3, v0
    v_lshlrev_b32 v9, 3, v10
    v_lshl_add_u32 v9, v13, 7, v9
    v_lshlrev_b32 v10, 4, v10
    v_lshl_add_u32 v10, v13, 16, v10
    v_lshlrev_b32 v11, 5, v0
    s_lshl_b32 s11, s2, 6
    s_add_u32 s11, s11, 3145728
    v_mov_b32 v18, s88
    v_mov_b32 v19, s89
    v_mov_b32 v22, s88
    v_mov_b32 v23, s89
    v_mov_b32 v26, s88
    v_mov_b32 v27, s89
    v_mov_b32 v30, s88
    v_mov_b32 v31, s89
    v_mov_b32 v34, s88
    v_mov_b32 v35, s89
    s_setprio 3
    s_barrier
    ds_read_b128 v[96:99], v5 offset:12288
    ds_read_b128 v[100:103], v5 offset:12304
    ds_read_b128 v[104:107], v5 offset:12320
    ds_read_b128 v[108:111], v5 offset:12336
    ds_read_b128 v[112:115], v5 offset:12352
    ds_read_b128 v[116:119], v5 offset:12368
    ds_read_b64 v[64:65], v4 offset:4096
    ds_read_b64 v[66:67], v4 offset:4608
    ds_read_b64 v[68:69], v4 offset:5120
    ds_read_b64 v[70:71], v4 offset:5632
    ds_read_b64 v[72:73], v4 offset:6144
    ds_read_b64 v[74:75], v4 offset:6656
    ds_read_b64 v[76:77], v4 offset:7168
    ds_read_b64 v[78:79], v4 offset:7680
    ds_read_b64 v[80:81], v4 offset:8192
    ds_read_b64 v[82:83], v4 offset:8704
    ds_read_b64 v[84:85], v4 offset:9216
    ds_read_b64 v[86:87], v4 offset:9728
    s_waitcnt lgkmcnt(12)
    v_max3_f32 v36, v96, v104, v112
    v_max3_f32 v37, v98, v106, v114
    v_max3_f32 v38, v100, v108, v116
    v_max3_f32 v39, v102, v110, v118
    v_sub_f32 v96, v96, v36
    v_mul_f32 v96, s82, v96
    v_sub_f32 v98, v98, v37
    v_mul_f32 v98, s82, v98
    v_sub_f32 v100, v100, v38
    v_mul_f32 v100, s82, v100
    v_sub_f32 v102, v102, v39
    v_mul_f32 v102, s82, v102
    v_sub_f32 v104, v104, v36
    v_mul_f32 v104, s82, v104
    v_sub_f32 v106, v106, v37
    v_mul_f32 v106, s82, v106
    v_sub_f32 v108, v108, v38
    v_mul_f32 v108, s82, v108
    v_sub_f32 v110, v110, v39
    v_mul_f32 v110, s82, v110
    v_sub_f32 v112, v112, v36
    v_mul_f32 v112, s82, v112
    v_sub_f32 v114, v114, v37
    v_mul_f32 v114, s82, v114
    v_sub_f32 v116, v116, v38
    v_mul_f32 v116, s82, v116
    v_sub_f32 v118, v118, v39
    v_mul_f32 v118, s82, v118
    v_exp_f32 v96, v96
    v_exp_f32 v98, v98
    v_exp_f32 v100, v100
    v_exp_f32 v102, v102
    v_exp_f32 v104, v104
    v_exp_f32 v106, v106
    v_exp_f32 v108, v108
    v_exp_f32 v110, v110
    v_exp_f32 v112, v112
    v_exp_f32 v114, v114
    v_exp_f32 v116, v116
    v_exp_f32 v118, v118
    s_nop 0
    v_mul_f32 v40, v96, v97
    v_mul_f32 v41, v98, v99
    v_mul_f32 v42, v100, v101
    v_mul_f32 v43, v102, v103
    v_fmac_f32 v40, v104, v105
    v_fmac_f32 v41, v106, v107
    v_fmac_f32 v42, v108, v109
    v_fmac_f32 v43, v110, v111
    v_fmac_f32 v40, v112, v113
    v_fmac_f32 v41, v114, v115
    v_fmac_f32 v42, v116, v117
    v_fmac_f32 v43, v118, v119
    s_waitcnt lgkmcnt(0)
    v_mul_f32 v16, v96, v64
    v_mul_f32 v17, v96, v65
    v_mul_f32 v20, v98, v66
    v_mul_f32 v21, v98, v67
    v_mul_f32 v24, v100, v68
    v_mul_f32 v25, v100, v69
    v_mul_f32 v28, v102, v70
    v_mul_f32 v29, v102, v71
    v_fmac_f32 v16, v104, v72
    v_fmac_f32 v17, v104, v73
    v_fmac_f32 v20, v106, v74
    v_fmac_f32 v21, v106, v75
    v_fmac_f32 v24, v108, v76
    v_fmac_f32 v25, v108, v77
    v_fmac_f32 v28, v110, v78
    v_fmac_f32 v29, v110, v79
    v_fmac_f32 v16, v112, v80
    v_fmac_f32 v17, v112, v81
    v_fmac_f32 v20, v114, v82
    v_fmac_f32 v21, v114, v83
    v_fmac_f32 v24, v116, v84
    v_fmac_f32 v25, v116, v85
    v_fmac_f32 v28, v118, v86
    v_fmac_f32 v29, v118, v87
    buffer_store_dwordx4 v[16:19], v6, s[48:51], s10 offen sc1
    buffer_store_dwordx4 v[20:23], v6, s[48:51], s17 offen sc1
    buffer_store_dwordx4 v[24:27], v6, s[48:51], s18 offen sc1
    buffer_store_dwordx4 v[28:31], v6, s[48:51], s19 offen sc1
    v_mov_b32 v32, v36
    v_mov_b32 v33, v40
    v_cndmask_b32 v32, v32, v37, s[22:23]
    v_cndmask_b32 v33, v33, v41, s[22:23]
    v_cndmask_b32 v32, v32, v38, s[24:25]
    v_cndmask_b32 v33, v33, v42, s[24:25]
    v_cndmask_b32 v32, v32, v39, s[26:27]
    v_cndmask_b32 v33, v33, v43, s[26:27]
    s_mov_b64 exec, 0xffff
    buffer_store_dwordx4 v[32:35], v7, s[48:51], s9 offen sc1
    s_mov_b64 exec, -1
    s_mov_b32 s90, 65536
L_poll_19:
    buffer_load_dwordx4 v[80:83], v8, s[48:51], s15 offen offset:0 sc1
    buffer_load_dwordx4 v[84:87], v8, s[48:51], s15 offen offset:64 sc1
    buffer_load_dwordx4 v[88:91], v8, s[48:51], s15 offen offset:128 sc1
    buffer_load_dwordx4 v[92:95], v8, s[48:51], s15 offen offset:192 sc1
    s_waitcnt vmcnt(0)
    v_cmp_ne_u64 vcc, s[88:89], v[82:83]
    v_cmp_ne_u64 s[94:95], s[88:89], v[86:87]
    s_or_b64 vcc, vcc, s[94:95]
    v_cmp_ne_u64 s[94:95], s[88:89], v[90:91]
    s_or_b64 vcc, vcc, s[94:95]
    v_cmp_ne_u64 s[94:95], s[88:89], v[94:95]
    s_or_b64 vcc, vcc, s[94:95]
    s_cbranch_vccz L_pdone_20
    s_sleep 2
    s_sub_u32 s90, s90, 1
    s_cmp_lg_u32 s90, 0
    s_cbranch_scc1 L_poll_19
L_pdone_20:
    s_mov_b32 s90, 65536
L_poll_21:
    buffer_load_dwordx4 v[64:67], v1, s[48:51], s14 offen offset:0 sc1
    buffer_load_dwordx4 v[68:71], v1, s[48:51], s14 offen offset:1024 sc1
    buffer_load_dwordx4 v[72:75], v1, s[48:51], s14 offen offset:2048 sc1
    buffer_load_dwordx4 v[76:79], v1, s[48:51], s14 offen offset:3072 sc1
    s_waitcnt vmcnt(0)
    v_cmp_ne_u64 vcc, s[88:89], v[66:67]
    v_cmp_ne_u64 s[94:95], s[88:89], v[70:71]
    s_or_b64 vcc, vcc, s[94:95]
    v_cmp_ne_u64 s[94:95], s[88:89], v[74:75]
    s_or_b64 vcc, vcc, s[94:95]
    v_cmp_ne_u64 s[94:95], s[88:89], v[78:79]
    s_or_b64 vcc, vcc, s[94:95]
    s_cbranch_vccz L_pdone_22
    s_sub_u32 s90, s90, 1
    s_cmp_lg_u32 s90, 0
    s_cbranch_scc1 L_poll_21
L_pdone_22:
    v_max3_f32 v96, v80, v84, v88
    v_max_f32 v96, v96, v92
    v_mov_b32 v97, v96
    s_nop 1
    v_permlane16_swap_b32 v96, v97
    s_nop 0
    v_max_f32 v96, v96, v97
    v_mov_b32 v97, v96
    s_nop 1
    v_permlane32_swap_b32 v96, v97
    s_nop 0
    v_max_f32 v96, v96, v97
    v_sub_f32 v80, v80, v96
    v_mul_f32 v80, s82, v80
    v_sub_f32 v84, v84, v96
    v_mul_f32 v84, s82, v84
    v_sub_f32 v88, v88, v96
    v_mul_f32 v88, s82, v88
    v_sub_f32 v92, v92, v96
    v_mul_f32 v92, s82, v92
    v_exp_f32 v80, v80
    v_exp_f32 v84, v84
    v_exp_f32 v88, v88
    v_exp_f32 v92, v92
    s_nop 0
    v_mul_f32 v96, v80, v81
    v_mul_f32 v97, v80, v64
    v_mul_f32 v98, v80, v65
    v_fmac_f32 v96, v84, v85
    v_fmac_f32 v97, v84, v68
    v_fmac_f32 v98, v84, v69
    v_fmac_f32 v96, v88, v89
    v_fmac_f32 v97, v88, v72
    v_fmac_f32 v98, v88, v73
    v_fmac_f32 v96, v92, v93
    v_fmac_f32 v97, v92, v76
    v_fmac_f32 v98, v92, v77
    v_mov_b32 v99, v96
    v_mov_b32 v100, v97
    v_mov_b32 v101, v98
    s_nop 1
    v_permlane16_swap_b32 v96, v99
    v_permlane16_swap_b32 v97, v100
    v_permlane16_swap_b32 v98, v101
    s_nop 0
    v_add_f32 v96, v96, v99
    v_add_f32 v97, v97, v100
    v_add_f32 v98, v98, v101
    v_mov_b32 v99, v96
    v_mov_b32 v100, v97
    v_mov_b32 v101, v98
    s_nop 1
    v_permlane32_swap_b32 v96, v99
    v_permlane32_swap_b32 v97, v100
    v_permlane32_swap_b32 v98, v101
    s_nop 0
    v_add_f32 v96, v96, v99
    v_add_f32 v97, v97, v100
    v_add_f32 v98, v98, v101
    v_rcp_f32 v99, v96
    s_nop 0
    v_mul_f32 v100, v97, v99
    v_mul_f32 v101, v98, v99
    v_fma_f32 v97, -v100, v96, v97
    v_fma_f32 v98, -v101, v96, v98
    v_fma_f32 v97, v97, v99, v100
    v_fma_f32 v98, v98, v99, v101
    v_cvt_pk_bf16_f32 v96, v97, v98
    v_mov_b32 v16, 0
    v_mov_b32 v17, 0
    v_mov_b32 v20, 0
    v_mov_b32 v21, 0
    v_mov_b32 v24, 0
    v_mov_b32 v25, 0
    v_mov_b32 v28, 0
    v_mov_b32 v29, 0
    v_readlane_b32 s16, v96, 0
    v_readlane_b32 s17, v96, 1
    v_readlane_b32 s18, v96, 2
    v_readlane_b32 s19, v96, 3
    v_readlane_b32 s20, v96, 4
    v_readlane_b32 s21, v96, 5
    v_readlane_b32 s22, v96, 6
    v_readlane_b32 s23, v96, 7
    v_readlane_b32 s24, v96, 8
    v_readlane_b32 s25, v96, 9
    v_readlane_b32 s26, v96, 10
    v_readlane_b32 s27, v96, 11
    v_readlane_b32 s28, v96, 12
    v_readlane_b32 s29, v96, 13
    v_readlane_b32 s30, v96, 14
    v_readlane_b32 s31, v96, 15
    s_nop 1
    v_dot2c_f32_bf16 v16, s16, v128
    v_dot2c_f32_bf16 v17, s16, v132
    v_dot2c_f32_bf16 v20, s16, v129
    v_dot2c_f32_bf16 v21, s16, v133
    v_dot2c_f32_bf16 v24, s16, v130
    v_dot2c_f32_bf16 v25, s16, v134
    v_dot2c_f32_bf16 v28, s16, v131
    v_dot2c_f32_bf16 v29, s16, v135
    v_dot2c_f32_bf16 v16, s17, v136
    v_dot2c_f32_bf16 v17, s17, v140
    v_dot2c_f32_bf16 v20, s17, v137
    v_dot2c_f32_bf16 v21, s17, v141
    v_dot2c_f32_bf16 v24, s17, v138
    v_dot2c_f32_bf16 v25, s17, v142
    v_dot2c_f32_bf16 v28, s17, v139
    v_dot2c_f32_bf16 v29, s17, v143
    v_dot2c_f32_bf16 v16, s18, v144
    v_dot2c_f32_bf16 v17, s18, v148
    v_dot2c_f32_bf16 v20, s18, v145
    v_dot2c_f32_bf16 v21, s18, v149
    v_dot2c_f32_bf16 v24, s18, v146
    v_dot2c_f32_bf16 v25, s18, v150
    v_dot2c_f32_bf16 v28, s18, v147
    v_dot2c_f32_bf16 v29, s18, v151
    v_dot2c_f32_bf16 v16, s19, v152
    v_dot2c_f32_bf16 v17, s19, v156
    v_dot2c_f32_bf16 v20, s19, v153
    v_dot2c_f32_bf16 v21, s19, v157
    v_dot2c_f32_bf16 v24, s19, v154
    v_dot2c_f32_bf16 v25, s19, v158
    v_dot2c_f32_bf16 v28, s19, v155
    v_dot2c_f32_bf16 v29, s19, v159
    v_dot2c_f32_bf16 v16, s20, v160
    v_dot2c_f32_bf16 v17, s20, v164
    v_dot2c_f32_bf16 v20, s20, v161
    v_dot2c_f32_bf16 v21, s20, v165
    v_dot2c_f32_bf16 v24, s20, v162
    v_dot2c_f32_bf16 v25, s20, v166
    v_dot2c_f32_bf16 v28, s20, v163
    v_dot2c_f32_bf16 v29, s20, v167
    v_dot2c_f32_bf16 v16, s21, v168
    v_dot2c_f32_bf16 v17, s21, v172
    v_dot2c_f32_bf16 v20, s21, v169
    v_dot2c_f32_bf16 v21, s21, v173
    v_dot2c_f32_bf16 v24, s21, v170
    v_dot2c_f32_bf16 v25, s21, v174
    v_dot2c_f32_bf16 v28, s21, v171
    v_dot2c_f32_bf16 v29, s21, v175
    v_dot2c_f32_bf16 v16, s22, v176
    v_dot2c_f32_bf16 v17, s22, v180
    v_dot2c_f32_bf16 v20, s22, v177
    v_dot2c_f32_bf16 v21, s22, v181
    v_dot2c_f32_bf16 v24, s22, v178
    v_dot2c_f32_bf16 v25, s22, v182
    v_dot2c_f32_bf16 v28, s22, v179
    v_dot2c_f32_bf16 v29, s22, v183
    v_dot2c_f32_bf16 v16, s23, v184
    v_dot2c_f32_bf16 v17, s23, v188
    v_dot2c_f32_bf16 v20, s23, v185
    v_dot2c_f32_bf16 v21, s23, v189
    v_dot2c_f32_bf16 v24, s23, v186
    v_dot2c_f32_bf16 v25, s23, v190
    v_dot2c_f32_bf16 v28, s23, v187
    v_dot2c_f32_bf16 v29, s23, v191
    v_dot2c_f32_bf16 v16, s24, v192
    v_dot2c_f32_bf16 v17, s24, v196
    v_dot2c_f32_bf16 v20, s24, v193
    v_dot2c_f32_bf16 v21, s24, v197
    v_dot2c_f32_bf16 v24, s24, v194
    v_dot2c_f32_bf16 v25, s24, v198
    v_dot2c_f32_bf16 v28, s24, v195
    v_dot2c_f32_bf16 v29, s24, v199
    v_dot2c_f32_bf16 v16, s25, v200
    v_dot2c_f32_bf16 v17, s25, v204
    v_dot2c_f32_bf16 v20, s25, v201
    v_dot2c_f32_bf16 v21, s25, v205
    v_dot2c_f32_bf16 v24, s25, v202
    v_dot2c_f32_bf16 v25, s25, v206
    v_dot2c_f32_bf16 v28, s25, v203
    v_dot2c_f32_bf16 v29, s25, v207
    v_dot2c_f32_bf16 v16, s26, v208
    v_dot2c_f32_bf16 v17, s26, v212
    v_dot2c_f32_bf16 v20, s26, v209
    v_dot2c_f32_bf16 v21, s26, v213
    v_dot2c_f32_bf16 v24, s26, v210
    v_dot2c_f32_bf16 v25, s26, v214
    v_dot2c_f32_bf16 v28, s26, v211
    v_dot2c_f32_bf16 v29, s26, v215
    v_dot2c_f32_bf16 v16, s27, v216
    v_dot2c_f32_bf16 v17, s27, v220
    v_dot2c_f32_bf16 v20, s27, v217
    v_dot2c_f32_bf16 v21, s27, v221
    v_dot2c_f32_bf16 v24, s27, v218
    v_dot2c_f32_bf16 v25, s27, v222
    v_dot2c_f32_bf16 v28, s27, v219
    v_dot2c_f32_bf16 v29, s27, v223
    v_dot2c_f32_bf16 v16, s28, v224
    v_dot2c_f32_bf16 v17, s28, v228
    v_dot2c_f32_bf16 v20, s28, v225
    v_dot2c_f32_bf16 v21, s28, v229
    v_dot2c_f32_bf16 v24, s28, v226
    v_dot2c_f32_bf16 v25, s28, v230
    v_dot2c_f32_bf16 v28, s28, v227
    v_dot2c_f32_bf16 v29, s28, v231
    v_dot2c_f32_bf16 v16, s29, v232
    v_dot2c_f32_bf16 v17, s29, v236
    v_dot2c_f32_bf16 v20, s29, v233
    v_dot2c_f32_bf16 v21, s29, v237
    v_dot2c_f32_bf16 v24, s29, v234
    v_dot2c_f32_bf16 v25, s29, v238
    v_dot2c_f32_bf16 v28, s29, v235
    v_dot2c_f32_bf16 v29, s29, v239
    v_dot2c_f32_bf16 v16, s30, v240
    v_dot2c_f32_bf16 v17, s30, v244
    v_dot2c_f32_bf16 v20, s30, v241
    v_dot2c_f32_bf16 v21, s30, v245
    v_dot2c_f32_bf16 v24, s30, v242
    v_dot2c_f32_bf16 v25, s30, v246
    v_dot2c_f32_bf16 v28, s30, v243
    v_dot2c_f32_bf16 v29, s30, v247
    v_dot2c_f32_bf16 v16, s31, v248
    v_dot2c_f32_bf16 v17, s31, v252
    v_dot2c_f32_bf16 v20, s31, v249
    v_dot2c_f32_bf16 v21, s31, v253
    v_dot2c_f32_bf16 v24, s31, v250
    v_dot2c_f32_bf16 v25, s31, v254
    v_dot2c_f32_bf16 v28, s31, v251
    v_dot2c_f32_bf16 v29, s31, v255
    s_nop 2
    ds_write_b64 v11, v[16:17] offset:4096
    ds_write_b64 v11, v[20:21] offset:4104
    ds_write_b64 v11, v[24:25] offset:4112
    ds_write_b64 v11, v[28:29] offset:4120
    s_add_u32 s17, s11, 16384
    s_add_u32 s18, s11, 32768
    s_add_u32 s19, s11, 49152
    s_waitcnt lgkmcnt(0)
    ds_read_b64 v[16:17], v9 offset:4096
    ds_read_b64 v[20:21], v9 offset:4128
    ds_read_b64 v[24:25], v9 offset:4160
    ds_read_b64 v[28:29], v9 offset:4192
    s_waitcnt lgkmcnt(0)
    buffer_store_dwordx4 v[16:19], v10, s[48:51], s11 offen sc1
    buffer_store_dwordx4 v[20:23], v10, s[48:51], s17 offen sc1
    buffer_store_dwordx4 v[24:27], v10, s[48:51], s18 offen sc1
    buffer_store_dwordx4 v[28:31], v10, s[48:51], s19 offen sc1
    s_cmp_lg_u32 s91, 1
    s_cbranch_scc1 L_hend
    s_lshl_b32 s14, s85, 14
    s_add_u32 s14, s14, 3145728
    s_add_u32 s15, s14, 4096
    s_add_u32 s16, s15, 4096
    s_add_u32 s17, s16, 4096
    s_mov_b64 s[72:73], -1
    s_mov_b64 s[74:75], -1
    s_mov_b64 s[96:97], -1
    s_mov_b64 s[98:99], -1
    s_mov_b32 s90, 65536
L_poll_23:
    s_mov_b64 exec, s[72:73]
    s_cbranch_execz L_sk_24
    buffer_load_dwordx4 v[64:67], v1, s[48:51], s14 offen offset:0 sc1
    buffer_load_dwordx4 v[68:71], v1, s[48:51], s14 offen offset:1024 sc1
    buffer_load_dwordx4 v[72:75], v1, s[48:51], s14 offen offset:2048 sc1
    buffer_load_dwordx4 v[76:79], v1, s[48:51], s14 offen offset:3072 sc1
L_sk_24:
    s_mov_b64 exec, s[74:75]
    s_cbranch_execz L_sk_25
    buffer_load_dwordx4 v[80:83], v1, s[48:51], s15 offen offset:0 sc1
    buffer_load_dwordx4 v[84:87], v1, s[48:51], s15 offen offset:1024 sc1
    buffer_load_dwordx4 v[88:91], v1, s[48:51], s15 offen offset:2048 sc1
    buffer_load_dwordx4 v[92:95], v1, s[48:51], s15 offen offset:3072 sc1
L_sk_25:
    s_mov_b64 exec, s[96:97]
    s_cbranch_execz L_sk_26
    buffer_load_dwordx4 v[96:99], v1, s[48:51], s16 offen offset:0 sc1
    buffer_load_dwordx4 v[100:103], v1, s[48:51], s16 offen offset:1024 sc1
    buffer_load_dwordx4 v[104:107], v1, s[48:51], s16 offen offset:2048 sc1
    buffer_load_dwordx4 v[108:111], v1, s[48:51], s16 offen offset:3072 sc1
L_sk_26:
    s_mov_b64 exec, s[98:99]
    s_cbranch_execz L_sk_27
    buffer_load_dwordx4 v[112:115], v1, s[48:51], s17 offen offset:0 sc1
    buffer_load_dwordx4 v[116:119], v1, s[48:51], s17 offen offset:1024 sc1
    buffer_load_dwordx4 v[120:123], v1, s[48:51], s17 offen offset:2048 sc1
    buffer_load_dwordx4 v[124:127], v1, s[48:51], s17 offen offset:3072 sc1
L_sk_27:
    s_waitcnt vmcnt(0)
    s_mov_b64 exec, s[72:73]
    v_cmp_ne_u64 vcc, s[88:89], v[66:67]
    v_cmp_ne_u64 s[94:95], s[88:89], v[70:71]
    s_or_b64 vcc, vcc, s[94:95]
    v_cmp_ne_u64 s[94:95], s[88:89], v[74:75]
    s_or_b64 vcc, vcc, s[94:95]
    v_cmp_ne_u64 s[94:95], s[88:89], v[78:79]
    s_or_b64 vcc, vcc, s[94:95]
    s_mov_b64 s[72:73], vcc
    s_mov_b64 exec, s[74:75]
    v_cmp_ne_u64 vcc, s[88:89], v[82:83]
    v_cmp_ne_u64 s[94:95], s[88:89], v[86:87]
    s_or_b64 vcc, vcc, s[94:95]
    v_cmp_ne_u64 s[94:95], s[88:89], v[90:91]
    s_or_b64 vcc, vcc, s[94:95]
    v_cmp_ne_u64 s[94:95], s[88:89], v[94:95]
    s_or_b64 vcc, vcc, s[94:95]
    s_mov_b64 s[74:75], vcc
    s_mov_b64 exec, s[96:97]
    v_cmp_ne_u64 vcc, s[88:89], v[98:99]
    v_cmp_ne_u64 s[94:95], s[88:89], v[102:103]
    s_or_b64 vcc, vcc, s[94:95]
    v_cmp_ne_u64 s[94:95], s[88:89], v[106:107]
    s_or_b64 vcc, vcc, s[94:95]
    v_cmp_ne_u64 s[94:95], s[88:89], v[110:111]
    s_or_b64 vcc, vcc, s[94:95]
    s_mov_b64 s[96:97], vcc
    s_mov_b64 exec, s[98:99]
    v_cmp_ne_u64 vcc, s[88:89], v[114:115]
    v_cmp_ne_u64 s[94:95], s[88:89], v[118:119]
    s_or_b64 vcc, vcc, s[94:95]
    v_cmp_ne_u64 s[94:95], s[88:89], v[122:123]
    s_or_b64 vcc, vcc, s[94:95]
    v_cmp_ne_u64 s[94:95], s[88:89], v[126:127]
    s_or_b64 vcc, vcc, s[94:95]
    s_mov_b64 s[98:99], vcc
    s_mov_b64 exec, -1
    s_mov_b64 vcc, s[72:73]
    s_or_b64 vcc, vcc, s[74:75]
    s_or_b64 vcc, vcc, s[96:97]
    s_or_b64 vcc, vcc, s[98:99]
    s_cbranch_vccz L_pdone_28
    s_sleep 2
    s_sub_u32 s90, s90, 1
    s_cmp_lg_u32 s90, 0
    s_cbranch_scc1 L_poll_23
L_pdone_28:
    v_add_f32 v64, v64, v68
    v_add_f32 v64, v64, v72
    v_add_f32 v64, v64, v76
    v_add_f32 v64, v64, v80
    v_add_f32 v64, v64, v84
    v_add_f32 v64, v64, v88
    v_add_f32 v64, v64, v92
    v_add_f32 v65, v65, v69
    v_add_f32 v65, v65, v73
    v_add_f32 v65, v65, v77
    v_add_f32 v65, v65, v81
    v_add_f32 v65, v65, v85
    v_add_f32 v65, v65, v89
    v_add_f32 v65, v65, v93
    v_add_f32 v96, v96, v100
    v_add_f32 v96, v96, v104
    v_add_f32 v96, v96, v108
    v_add_f32 v96, v96, v112
    v_add_f32 v96, v96, v116
    v_add_f32 v96, v96, v120
    v_add_f32 v96, v96, v124
    v_add_f32 v97, v97, v101
    v_add_f32 v97, v97, v105
    v_add_f32 v97, v97, v109
    v_add_f32 v97, v97, v113
    v_add_f32 v97, v97, v117
    v_add_f32 v97, v97, v121
    v_add_f32 v97, v97, v125
    v_add_f32_dpp v64, v64, v64 row_ror:4 row_mask:0xf bank_mask:0xf
    v_add_f32_dpp v65, v65, v65 row_ror:4 row_mask:0xf bank_mask:0xf
    v_add_f32_dpp v96, v96, v96 row_ror:4 row_mask:0xf bank_mask:0xf
    v_add_f32_dpp v97, v97, v97 row_ror:4 row_mask:0xf bank_mask:0xf
    v_add_f32_dpp v64, v64, v64 row_ror:8 row_mask:0xf bank_mask:0xf
    v_add_f32_dpp v65, v65, v65 row_ror:8 row_mask:0xf bank_mask:0xf
    v_add_f32_dpp v96, v96, v96 row_ror:8 row_mask:0xf bank_mask:0xf
    v_add_f32_dpp v97, v97, v97 row_ror:8 row_mask:0xf bank_mask:0xf
    v_mov_b32 v66, v64
    v_mov_b32 v67, v65
    v_mov_b32 v98, v96
    v_mov_b32 v99, v97
    s_nop 1
    v_permlane16_swap_b32 v64, v66
    v_permlane16_swap_b32 v65, v67
    v_permlane16_swap_b32 v96, v98
    v_permlane16_swap_b32 v97, v99
    s_nop 0
    v_add_f32 v64, v64, v66
    v_add_f32 v65, v65, v67
    v_add_f32 v96, v96, v98
    v_add_f32 v97, v97, v99
    v_mov_b32 v66, v64
    v_mov_b32 v67, v65
    v_mov_b32 v98, v96
    v_mov_b32 v99, v97
    s_nop 1
    v_permlane32_swap_b32 v64, v66
    v_permlane32_swap_b32 v65, v67
    v_permlane32_swap_b32 v96, v98
    v_permlane32_swap_b32 v97, v99
    s_nop 0
    v_add_f32 v64, v64, v66
    v_add_f32 v65, v65, v67
    v_add_f32 v96, v96, v98
    v_add_f32 v97, v97, v99
    v_and_b32 v12, 4, v0
    v_cmp_eq_u32 vcc, 4, v12
    s_nop 1
    v_cndmask_b32 v16, v64, v96, vcc
    v_cndmask_b32 v17, v65, v97, vcc
    v_cvt_pk_bf16_f32 v16, v16, v16
    v_and_b32 v16, 0xffff0000, v16
    v_mul_f32 v16, v16, v52
    v_cvt_pk_bf16_f32 v16, v16, v16
    v_and_b32 v16, 0xffff0000, v16
    v_add_f32 v16, v16, v56
    v_cvt_pk_bf16_f32 v17, v17, v17
    v_and_b32 v17, 0xffff0000, v17
    v_mul_f32 v17, v17, v53
    v_cvt_pk_bf16_f32 v17, v17, v17
    v_and_b32 v17, 0xffff0000, v17
    v_add_f32 v17, v17, v57
    v_cvt_pk_bf16_f32 v4, v16, v17
    s_lshl_b32 s12, s85, 4
    s_mov_b64 exec, 0xff
    buffer_store_dword v4, v58, s[64:67], s12 offen
L_hend:
L_end:
    s_endpgm
.section .rodata,"a"
.p2align 6
.amdhsa_kernel recurrent_scan__gqa_block_cached__glu_gated_swiglu__decode_kernel
  .amdhsa_next_free_vgpr 512
  .amdhsa_next_free_sgpr 102
  .amdhsa_accum_offset 256
  .amdhsa_group_segment_fixed_size 0
  .amdhsa_kernarg_size 96
  .amdhsa_user_sgpr_count 2
  .amdhsa_user_sgpr_kernarg_segment_ptr 1
  .amdhsa_system_sgpr_workgroup_id_x 1
  .amdhsa_float_denorm_mode_32 3
.end_amdhsa_kernel
```
